```python
import torch

def _softmax(x, axis=-1):
    return torch.softmax(x, dim=axis)
def _gelu(x):
    return torch.nn.functional.gelu(x, approximate="tanh")
def _silu(x):
    return torch.nn.functional.silu(x)
def _sigmoid(x):
    return torch.sigmoid(x)
def _layernorm(x, axis=-1, eps=1e-5):
    m = x.mean(dim=axis, keepdim=True)
    v = x.var(dim=axis, keepdim=True, unbiased=False)
    return (x - m) / torch.sqrt(v + eps)
def _scatter_add(tgt, idx, src, axis=0):
    return tgt.clone().index_add_(axis, idx, src)
def _segment_sum(src, seg, n):
    out = torch.zeros((n,) + src.shape[1:], dtype=src.dtype)
    return out.index_add_(0, seg, src)
def _pad(x, pw):
    flat = tuple(v for pair in reversed(pw) for v in pair)
    return torch.nn.functional.pad(x, flat)

kernel_name = 'parallel_sum__gqa_block_cached__glu_gated_reglu__decode'

def setup_inputs():

    _w = (lambda a: (lambda t: t.to(torch.bfloat16) if t.is_floating_point() else t)(torch.as_tensor(a)))
    def _A_setup():
        B, Sq, D = 4, 1, 640
        Hq, Hkv, Sk, Dh = 32, 32, 8192, 128
        assert Hq % Hkv == 0, (Hq, Hkv)
        return {
            "x": _w((lambda *s: torch.randn(*s, dtype=torch.bfloat16) * 0.05)(B, Sq, D)),
            "k_cache": _w((lambda *s: torch.randn(*s, dtype=torch.bfloat16) * 1.6)(B, Hkv, Sk, Dh)),
            "v_cache": _w((lambda *s: torch.randn(*s, dtype=torch.bfloat16) * 0.8)(B, Hkv, Sk, Dh)),
            "wq": _w((lambda *s: torch.randn(*s, dtype=torch.bfloat16) * 1.6)(D, Hq * Dh) * (D ** -0.5)),
            "wo": _w((lambda *s: torch.randn(*s, dtype=torch.bfloat16) * 0.8)(Hq * Dh, D) * ((Hq * Dh) ** -0.5)),
        }
    _A_in = _A_setup()

    def _B_setup():
        B, S, D, F = 4, 1, 640, 1728
        return {
            "x": _w((lambda *s: torch.randn(*s, dtype=torch.bfloat16) * 0.05)(B, S, D)),
            "W_gate": _w((lambda *s: torch.randn(*s, dtype=torch.bfloat16) * 0.4)(D, F) * (2.0 / D) ** 0.5),
            "W_up": _w((lambda *s: torch.randn(*s, dtype=torch.bfloat16) * 0.4)(D, F) * (2.0 / D) ** 0.5),
            "W_down": _w((lambda *s: torch.randn(*s, dtype=torch.bfloat16) * 0.4)(F, D) * (1.0 / F) ** 0.5),
        }
    _B_in = _B_setup()

    return {
        "A_x": _A_in["x"],
        "A_k_cache": _A_in["k_cache"],
        "A_v_cache": _A_in["v_cache"],
        "A_wq": _A_in["wq"],
        "A_wo": _A_in["wo"],
        "B_x": _B_in["x"],
        "B_W_gate": _B_in["W_gate"],
        "B_W_up": _B_in["W_up"],
        "B_W_down": _B_in["W_down"],
    }

def reference(A_x, A_k_cache, A_v_cache, A_wq, A_wo, B_x, B_W_gate, B_W_up, B_W_down):
    def _A_ref(x, k_cache, v_cache, wq, wo):
        B, Sq, D = x.shape
        Hq, Dh = 32, 128
        Hkv = k_cache.shape[1]
        rep = Hq // Hkv
        q = (lambda x, *d: x.permute(*d))((x @ wq).reshape(B, Sq, Hq, Dh), 0, 2, 1, 3)
        k = (lambda x, n, axis: torch.repeat_interleave(x, n, dim=axis))(k_cache, rep, axis=1)
        v = (lambda x, n, axis: torch.repeat_interleave(x, n, dim=axis))(v_cache, rep, axis=1)
        scores = torch.einsum("bhqd,bhkd->bhqk", q, k) * (Dh ** -0.5)
        p = _softmax(scores, axis=-1)
        o = torch.einsum("bhqk,bhkd->bhqd", p, v)
        return (lambda x, *d: x.permute(*d))(o, 0, 2, 1, 3).reshape(B, Sq, Hq * Dh) @ wo

    def _B_ref(x, W_gate, W_up, W_down):
        gate = torch.einsum("bsd,df->bsf", x, W_gate)
        up = torch.einsum("bsd,df->bsf", x, W_up)
        gate = gate * (lambda x, dt: x.to(dt))(gate > 0, gate.dtype)
        h = gate * up
        return torch.einsum("bsf,fd->bsd", h, W_down)

    x = A_x
    xn = _layernorm(x, axis=-1)
    return x + _A_ref(xn, A_k_cache, A_v_cache, A_wq, A_wo) + _B_ref(xn, B_W_gate, B_W_up, B_W_down)
```

```asm
; @launch grid=(256,1,1) block=(512,1,1) lds=45056
.amdgcn_target "amdgcn-amd-amdhsa--gfx950"
.text
.globl parallel_sum__gqa_block_cached__glu_gated_reglu__decode_kernel
.p2align 8
.type parallel_sum__gqa_block_cached__glu_gated_reglu__decode_kernel,@function
parallel_sum__gqa_block_cached__glu_gated_reglu__decode_kernel:
    s_cmp_ge_u32 s2, 256
    s_cbranch_scc1 L_exit
    s_load_dwordx16 s[64:79], s[0:1], 0
    s_load_dwordx8 s[80:87], s[0:1], 64
    v_lshrrev_b32 v1, 6, v0
    v_and_b32 v0, 63, v0
    v_readfirstlane_b32 s3, v1
    s_and_b32 s40, s2, 7
    s_lshr_b32 s41, s2, 3
    s_lshr_b32 s43, s41, 1
    s_and_b32 s43, s43, 3
    s_lshl_b32 s45, s43, 3
    s_add_u32 s45, s45, s40
    s_lshr_b32 s44, s41, 3
    s_and_b32 s46, s41, 1
    s_lshl_b32 s47, s44, 5
    s_add_u32 s47, s47, s45
    s_lshl_b32 s47, s47, 1
    s_add_u32 s47, s47, s46
    s_cmp_ge_u32 s3, 4
    s_cbranch_scc1 L_helper
    v_and_b32 v7, 15, v0
    v_lshrrev_b32 v8, 4, v0
    v_lshrrev_b32 v9, 2, v7
    v_lshlrev_b32 v1, 8, v9
    v_lshlrev_b32 v10, 6, v8
    v_or_b32 v1, v1, v10
    v_and_b32 v10, 3, v7
    v_lshlrev_b32 v10, 4, v10
    v_or_b32 v1, v1, v10
    v_lshlrev_b32 v2, 4, v0
    s_lshl_b32 s16, s47, 20
    s_lshl_b32 s17, s3, 12
    s_add_u32 s16, s16, s17
    s_mov_b32 s17, s16
    s_waitcnt lgkmcnt(0)
    s_mov_b32 s8, s66
    s_mov_b32 s9, s67
    s_mov_b32 s10, 0x10000000
    s_mov_b32 s11, 0x20000
    s_mov_b32 s12, s68
    s_mov_b32 s13, s69
    s_mov_b32 s14, 0x10000000
    s_mov_b32 s15, 0x20000
    s_add_u32 s14, s47, 1
    s_lshl_b32 s14, s14, 20
    s_mov_b32 s24, s86
    s_mov_b32 s25, s87
    s_mov_b32 s26, 0x40000000
    s_mov_b32 s27, 0x20000
    v_mov_b32 v56, -1
    v_mov_b32 v57, -1
    v_mov_b32 v58, -1
    v_mov_b32 v59, -1
    v_lshlrev_b32 v60, 4, v0
    s_cmp_eq_u32 s3, 3
    s_cbranch_scc1 L_clr3_1
    s_mul_i32 s48, s47, 2560
    s_add_u32 s48, s48, 1048576
    s_lshl_b32 s49, s3, 10
    s_add_u32 s48, s48, s49
    s_cmp_eq_u32 s3, 2
    s_cselect_b32 exec_hi, 0, -1
    buffer_store_dwordx4 v[56:59], v60, s[24:27], s48 offen sc1
    s_mov_b64 exec, -1
    s_branch L_clrd_2
L_clr3_1:
    s_lshl_b32 s48, s47, 7
    s_add_u32 s48, s48, 1703936
    s_mov_b64 exec, 1
    buffer_store_dwordx2 v[56:57], v60, s[24:27], s48 offen sc1
    s_lshr_b32 s49, s2, 3
    s_and_b32 s50, s2, 7
    s_lshl_b32 s50, s50, 8
    s_add_u32 s50, s50, 2621440
    s_lshl_b32 s49, s49, 2
    s_add_u32 s49, s49, s50
    v_mov_b32 v58, 0
    buffer_store_dword v58, v60, s[24:27], s49 offen sc1
    s_cmp_ge_u32 s2, 248
    s_cbranch_scc0 L_nolead_3
    buffer_store_dword v58, v60, s[24:27], s50 offen offset:128 sc1
    s_and_b32 s49, s2, 7
    s_lshl_b32 s49, s49, 8
    s_add_u32 s49, s49, 262144
    buffer_store_dword v58, v60, s[24:27], s49 offen sc1
L_nolead_3:
    s_mov_b64 exec, -1
L_clrd_2:
    buffer_load_dwordx4 v[64:67], v1, s[8:11], s16 offen offset:0 nt
    buffer_load_dwordx4 v[68:71], v1, s[8:11], s16 offen offset:1024 nt
    buffer_load_dwordx4 v[72:75], v1, s[8:11], s16 offen offset:2048 nt
    buffer_load_dwordx4 v[76:79], v1, s[8:11], s16 offen offset:3072 nt
    s_add_u32 s16, s16, 0x4000
    s_waitcnt vmcnt(4)
    s_barrier
    buffer_load_dwordx4 v[80:83], v1, s[8:11], s16 offen offset:0 nt
    buffer_load_dwordx4 v[84:87], v1, s[8:11], s16 offen offset:1024 nt
    buffer_load_dwordx4 v[88:91], v1, s[8:11], s16 offen offset:2048 nt
    buffer_load_dwordx4 v[92:95], v1, s[8:11], s16 offen offset:3072 nt
    s_add_u32 s16, s16, 0x4000
    buffer_load_dwordx4 v[96:99], v1, s[8:11], s16 offen offset:0 nt
    buffer_load_dwordx4 v[100:103], v1, s[8:11], s16 offen offset:1024 nt
    buffer_load_dwordx4 v[104:107], v1, s[8:11], s16 offen offset:2048 nt
    buffer_load_dwordx4 v[108:111], v1, s[8:11], s16 offen offset:3072 nt
    s_add_u32 s16, s16, 0x4000
    buffer_load_dwordx4 v[112:115], v1, s[8:11], s16 offen offset:0 nt
    buffer_load_dwordx4 v[116:119], v1, s[8:11], s16 offen offset:1024 nt
    buffer_load_dwordx4 v[120:123], v1, s[8:11], s16 offen offset:2048 nt
    buffer_load_dwordx4 v[124:127], v1, s[8:11], s16 offen offset:3072 nt
    s_add_u32 s16, s16, 0x4000
    s_mov_b32 s60, 0xaaaaaaaa
    s_mov_b32 s61, 0xaaaaaaaa
    v_mov_b32 v7, 0xffff
    v_mov_b32 v8, 0xffff0000
    v_cndmask_b32_e64 v7, v7, v8, s[60:61]
    s_mov_b32 s60, 0x3030303
    s_mov_b32 s61, 0x3030303
    v_cndmask_b32_e64 v12, 0, v7, s[60:61]
    s_mov_b32 s60, 0xc0c0c0c
    s_mov_b32 s61, 0xc0c0c0c
    v_cndmask_b32_e64 v13, 0, v7, s[60:61]
    s_mov_b32 s60, 0x30303030
    s_mov_b32 s61, 0x30303030
    v_cndmask_b32_e64 v14, 0, v7, s[60:61]
    s_mov_b32 s60, 0xc0c0c0c0
    s_mov_b32 s61, 0xc0c0c0c0
    v_cndmask_b32_e64 v15, 0, v7, s[60:61]
    s_mov_b32 s48, 0x22222222
    s_mov_b32 s49, 0x22222222
    s_mov_b32 s50, 0x44444444
    s_mov_b32 s51, 0x44444444
    s_mov_b32 s52, 0x88888888
    s_mov_b32 s53, 0x88888888
    v_and_b32 v7, 15, v0
    v_lshrrev_b32 v8, 4, v0
    v_lshrrev_b32 v9, 2, v7
    v_and_b32 v10, 3, v7
    v_lshlrev_b32 v9, 4, v9
    v_lshlrev_b32 v3, 2, v8
    v_add_u32 v3, v3, v9
    v_add_u32 v3, v3, v10
    v_lshlrev_b32 v3, 2, v3
    s_lshl_b32 s18, s3, 12
    s_add_u32 s18, s18, 16384
    v_add_u32 v3, s18, v3
    v_lshlrev_b32 v4, 2, v0
    v_add_u32 v4, s18, v4
    v_mov_b32 v5, 0xff800000
    v_lshlrev_b32 v9, 2, v8
    v_add_u32 v9, v9, v10
    v_lshlrev_b32 v9, 5, v9
    s_lshl_b32 s21, s3, 8
    s_add_u32 s21, s21, 3072
    v_lshlrev_b32 v53, 2, v0
    v_add_u32 v53, s21, v53
    s_lshl_b32 s21, s3, 2
    s_add_u32 s21, s21, 2304
    v_mov_b32 v55, s21
    v_mov_b32 v52, 0
    v_mov_b32 v54, 5
    ds_write_b32 v53, v52
    ds_write_b32 v55, v54
    s_waitcnt lgkmcnt(0)
    s_barrier
    ds_read_b128 v[192:195], v9 offset:0
    ds_read_b128 v[196:199], v9 offset:16
    ds_read_b128 v[200:203], v9 offset:512
    ds_read_b128 v[204:207], v9 offset:528
    ds_read_b128 v[208:211], v9 offset:1024
    ds_read_b128 v[212:215], v9 offset:1040
    ds_read_b128 v[216:219], v9 offset:1536
    ds_read_b128 v[220:223], v9 offset:1552
    s_waitcnt lgkmcnt(0)
    v_add_f32 v192, v192, v200
    v_add_f32 v208, v208, v216
    v_add_f32 v193, v193, v201
    v_add_f32 v209, v209, v217
    v_add_f32 v194, v194, v202
    v_add_f32 v210, v210, v218
    v_add_f32 v195, v195, v203
    v_add_f32 v211, v211, v219
    v_add_f32 v196, v196, v204
    v_add_f32 v212, v212, v220
    v_add_f32 v197, v197, v205
    v_add_f32 v213, v213, v221
    v_add_f32 v198, v198, v206
    v_add_f32 v214, v214, v222
    v_add_f32 v199, v199, v207
    v_add_f32 v215, v215, v223
    v_add_f32 v192, v192, v208
    v_add_f32 v193, v193, v209
    v_add_f32 v194, v194, v210
    v_add_f32 v195, v195, v211
    v_add_f32 v196, v196, v212
    v_add_f32 v197, v197, v213
    v_add_f32 v198, v198, v214
    v_add_f32 v199, v199, v215
    v_cvt_pk_bf16_f32 v200, v192, v193
    v_cvt_pk_bf16_f32 v201, v194, v195
    v_cvt_pk_bf16_f32 v202, v196, v197
    v_cvt_pk_bf16_f32 v203, v198, v199
    s_mov_b32 s60, 0xf000f
    s_mov_b32 s61, 0xf000f
    v_cndmask_b32_e64 v16, 0, v200, s[60:61]
    v_cndmask_b32_e64 v17, 0, v201, s[60:61]
    v_cndmask_b32_e64 v18, 0, v202, s[60:61]
    v_cndmask_b32_e64 v19, 0, v203, s[60:61]
    s_mov_b32 s60, 0xf000f0
    s_mov_b32 s61, 0xf000f0
    v_cndmask_b32_e64 v20, 0, v200, s[60:61]
    v_cndmask_b32_e64 v21, 0, v201, s[60:61]
    v_cndmask_b32_e64 v22, 0, v202, s[60:61]
    v_cndmask_b32_e64 v23, 0, v203, s[60:61]
    s_mov_b32 s60, 0xf000f00
    s_mov_b32 s61, 0xf000f00
    v_cndmask_b32_e64 v24, 0, v200, s[60:61]
    v_cndmask_b32_e64 v25, 0, v201, s[60:61]
    v_cndmask_b32_e64 v26, 0, v202, s[60:61]
    v_cndmask_b32_e64 v27, 0, v203, s[60:61]
    s_mov_b32 s60, 0xf000f000
    s_mov_b32 s61, 0xf000f000
    v_cndmask_b32_e64 v28, 0, v200, s[60:61]
    v_cndmask_b32_e64 v29, 0, v201, s[60:61]
    v_cndmask_b32_e64 v30, 0, v202, s[60:61]
    v_cndmask_b32_e64 v31, 0, v203, s[60:61]
    s_nop 1
    s_waitcnt vmcnt(15)
    v_mfma_f32_16x16x32_bf16 v[32:35], v[16:19], v[64:67], 0
    buffer_load_dwordx4 v[64:67], v1, s[8:11], s16 offen offset:0 nt
    s_waitcnt vmcnt(15)
    v_mfma_f32_16x16x32_bf16 v[32:35], v[20:23], v[68:71], v[32:35]
    buffer_load_dwordx4 v[68:71], v1, s[8:11], s16 offen offset:1024 nt
    s_waitcnt vmcnt(15)
    v_mfma_f32_16x16x32_bf16 v[32:35], v[24:27], v[72:75], v[32:35]
    buffer_load_dwordx4 v[72:75], v1, s[8:11], s16 offen offset:2048 nt
    s_waitcnt vmcnt(15)
    v_mfma_f32_16x16x32_bf16 v[32:35], v[28:31], v[76:79], v[32:35]
    buffer_load_dwordx4 v[76:79], v1, s[8:11], s16 offen offset:3072 nt
    s_add_u32 s16, s16, 0x4000
    s_nop 7
    v_mov_b32_dpp v7, v32 quad_perm:[0,0,0,0] row_mask:0xf bank_mask:0xf
    v_mov_b32_dpp v8, v34 quad_perm:[2,2,2,2] row_mask:0xf bank_mask:0xf
    s_nop 0
    v_add_f32_dpp v7, v33, v7 quad_perm:[1,1,1,1] row_mask:0xf bank_mask:0xf
    v_add_f32_dpp v8, v35, v8 quad_perm:[3,3,3,3] row_mask:0xf bank_mask:0xf
    v_add_f32 v6, v7, v8
    s_waitcnt vmcnt(15)
    v_mfma_f32_16x16x32_bf16 v[32:35], v[16:19], v[80:83], 0
    buffer_load_dwordx4 v[80:83], v1, s[8:11], s16 offen offset:0 nt
    s_waitcnt vmcnt(15)
    v_mfma_f32_16x16x32_bf16 v[32:35], v[20:23], v[84:87], v[32:35]
    s_waitcnt vmcnt(14)
    v_mfma_f32_16x16x32_bf16 v[32:35], v[24:27], v[88:91], v[32:35]
    s_waitcnt vmcnt(13)
    v_mfma_f32_16x16x32_bf16 v[32:35], v[28:31], v[92:95], v[32:35]
    s_nop 7
    v_mov_b32_dpp v7, v32 quad_perm:[0,0,0,0] row_mask:0xf bank_mask:0xf
    v_mov_b32_dpp v8, v34 quad_perm:[2,2,2,2] row_mask:0xf bank_mask:0xf
    s_nop 0
    v_add_f32_dpp v7, v33, v7 quad_perm:[1,1,1,1] row_mask:0xf bank_mask:0xf
    v_add_f32_dpp v8, v35, v8 quad_perm:[3,3,3,3] row_mask:0xf bank_mask:0xf
    v_add_f32 v7, v7, v8
    v_cndmask_b32_e64 v6, v6, v7, s[48:49]
    s_waitcnt vmcnt(12)
    v_mfma_f32_16x16x32_bf16 v[32:35], v[16:19], v[96:99], 0
    s_waitcnt vmcnt(11)
    v_mfma_f32_16x16x32_bf16 v[32:35], v[20:23], v[100:103], v[32:35]
    s_waitcnt vmcnt(10)
    v_mfma_f32_16x16x32_bf16 v[32:35], v[24:27], v[104:107], v[32:35]
    s_waitcnt vmcnt(9)
    v_mfma_f32_16x16x32_bf16 v[32:35], v[28:31], v[108:111], v[32:35]
    s_nop 7
    v_mov_b32_dpp v7, v32 quad_perm:[0,0,0,0] row_mask:0xf bank_mask:0xf
    v_mov_b32_dpp v8, v34 quad_perm:[2,2,2,2] row_mask:0xf bank_mask:0xf
    s_nop 0
    v_add_f32_dpp v7, v33, v7 quad_perm:[1,1,1,1] row_mask:0xf bank_mask:0xf
    v_add_f32_dpp v8, v35, v8 quad_perm:[3,3,3,3] row_mask:0xf bank_mask:0xf
    v_add_f32 v7, v7, v8
    v_cndmask_b32_e64 v6, v6, v7, s[50:51]
    s_waitcnt vmcnt(8)
    v_mfma_f32_16x16x32_bf16 v[32:35], v[16:19], v[112:115], 0
    s_waitcnt vmcnt(7)
    v_mfma_f32_16x16x32_bf16 v[32:35], v[20:23], v[116:119], v[32:35]
    s_waitcnt vmcnt(6)
    v_mfma_f32_16x16x32_bf16 v[32:35], v[24:27], v[120:123], v[32:35]
    s_waitcnt vmcnt(5)
    v_mfma_f32_16x16x32_bf16 v[32:35], v[28:31], v[124:127], v[32:35]
    s_nop 7
    v_mov_b32_dpp v7, v32 quad_perm:[0,0,0,0] row_mask:0xf bank_mask:0xf
    v_mov_b32_dpp v8, v34 quad_perm:[2,2,2,2] row_mask:0xf bank_mask:0xf
    s_nop 0
    v_add_f32_dpp v7, v33, v7 quad_perm:[1,1,1,1] row_mask:0xf bank_mask:0xf
    v_add_f32_dpp v8, v35, v8 quad_perm:[3,3,3,3] row_mask:0xf bank_mask:0xf
    v_add_f32 v7, v7, v8
    v_cndmask_b32_e64 v6, v6, v7, s[52:53]
    v_cvt_pk_bf16_f32 v6, v6, v6
    v_and_b32 v6, 0xffff0000, v6
    v_mul_f32 v6, 0x3db504f3, v6
    v_cvt_pk_bf16_f32 v6, v6, v6
    v_and_b32 v6, 0xffff0000, v6
    v_max_f32 v5, v5, v6
    ds_write_b32 v3, v6
    v_add_u32 v3, 0x100, v3
    s_mov_b32 s19, 14
L_K_4:
    s_waitcnt vmcnt(4)
    v_mfma_f32_16x16x32_bf16 v[32:35], v[16:19], v[64:67], 0
    buffer_load_dwordx4 v[84:87], v1, s[8:11], s16 offen offset:1024 nt
    s_waitcnt vmcnt(4)
    v_mfma_f32_16x16x32_bf16 v[32:35], v[20:23], v[68:71], v[32:35]
    buffer_load_dwordx4 v[88:91], v1, s[8:11], s16 offen offset:2048 nt
    s_waitcnt vmcnt(4)
    v_mfma_f32_16x16x32_bf16 v[32:35], v[24:27], v[72:75], v[32:35]
    buffer_load_dwordx4 v[92:95], v1, s[8:11], s16 offen offset:3072 nt
    s_add_u32 s16, s16, 0x4000
    s_waitcnt vmcnt(4)
    v_mfma_f32_16x16x32_bf16 v[32:35], v[28:31], v[76:79], v[32:35]
    buffer_load_dwordx4 v[96:99], v1, s[8:11], s16 offen offset:0 nt
    s_nop 7
    v_mov_b32_dpp v7, v32 quad_perm:[0,0,0,0] row_mask:0xf bank_mask:0xf
    v_mov_b32_dpp v8, v34 quad_perm:[2,2,2,2] row_mask:0xf bank_mask:0xf
    s_nop 0
    v_add_f32_dpp v7, v33, v7 quad_perm:[1,1,1,1] row_mask:0xf bank_mask:0xf
    v_add_f32_dpp v8, v35, v8 quad_perm:[3,3,3,3] row_mask:0xf bank_mask:0xf
    v_add_f32 v6, v7, v8
    s_waitcnt vmcnt(4)
    v_mfma_f32_16x16x32_bf16 v[32:35], v[16:19], v[80:83], 0
    buffer_load_dwordx4 v[100:103], v1, s[8:11], s16 offen offset:1024 nt
    s_waitcnt vmcnt(4)
    v_mfma_f32_16x16x32_bf16 v[32:35], v[20:23], v[84:87], v[32:35]
    buffer_load_dwordx4 v[104:107], v1, s[8:11], s16 offen offset:2048 nt
    s_waitcnt vmcnt(4)
    v_mfma_f32_16x16x32_bf16 v[32:35], v[24:27], v[88:91], v[32:35]
    buffer_load_dwordx4 v[108:111], v1, s[8:11], s16 offen offset:3072 nt
    s_add_u32 s16, s16, 0x4000
    s_waitcnt vmcnt(4)
    v_mfma_f32_16x16x32_bf16 v[32:35], v[28:31], v[92:95], v[32:35]
    buffer_load_dwordx4 v[112:115], v1, s[8:11], s16 offen offset:0 nt
    s_nop 7
    v_mov_b32_dpp v7, v32 quad_perm:[0,0,0,0] row_mask:0xf bank_mask:0xf
    v_mov_b32_dpp v8, v34 quad_perm:[2,2,2,2] row_mask:0xf bank_mask:0xf
    s_nop 0
    v_add_f32_dpp v7, v33, v7 quad_perm:[1,1,1,1] row_mask:0xf bank_mask:0xf
    v_add_f32_dpp v8, v35, v8 quad_perm:[3,3,3,3] row_mask:0xf bank_mask:0xf
    v_add_f32 v7, v7, v8
    v_cndmask_b32_e64 v6, v6, v7, s[48:49]
    s_waitcnt vmcnt(4)
    v_mfma_f32_16x16x32_bf16 v[32:35], v[16:19], v[96:99], 0
    buffer_load_dwordx4 v[116:119], v1, s[8:11], s16 offen offset:1024 nt
    s_waitcnt vmcnt(4)
    v_mfma_f32_16x16x32_bf16 v[32:35], v[20:23], v[100:103], v[32:35]
    buffer_load_dwordx4 v[120:123], v1, s[8:11], s16 offen offset:2048 nt
    s_waitcnt vmcnt(4)
    v_mfma_f32_16x16x32_bf16 v[32:35], v[24:27], v[104:107], v[32:35]
    buffer_load_dwordx4 v[124:127], v1, s[8:11], s16 offen offset:3072 nt
    s_add_u32 s16, s16, 0x4000
    s_waitcnt vmcnt(4)
    v_mfma_f32_16x16x32_bf16 v[32:35], v[28:31], v[108:111], v[32:35]
    buffer_load_dwordx4 v[64:67], v1, s[8:11], s16 offen offset:0 nt
    s_nop 7
    v_mov_b32_dpp v7, v32 quad_perm:[0,0,0,0] row_mask:0xf bank_mask:0xf
    v_mov_b32_dpp v8, v34 quad_perm:[2,2,2,2] row_mask:0xf bank_mask:0xf
    s_nop 0
    v_add_f32_dpp v7, v33, v7 quad_perm:[1,1,1,1] row_mask:0xf bank_mask:0xf
    v_add_f32_dpp v8, v35, v8 quad_perm:[3,3,3,3] row_mask:0xf bank_mask:0xf
    v_add_f32 v7, v7, v8
    v_cndmask_b32_e64 v6, v6, v7, s[50:51]
    s_waitcnt vmcnt(4)
    v_mfma_f32_16x16x32_bf16 v[32:35], v[16:19], v[112:115], 0
    buffer_load_dwordx4 v[68:71], v1, s[8:11], s16 offen offset:1024 nt
    s_waitcnt vmcnt(4)
    v_mfma_f32_16x16x32_bf16 v[32:35], v[20:23], v[116:119], v[32:35]
    buffer_load_dwordx4 v[72:75], v1, s[8:11], s16 offen offset:2048 nt
    s_waitcnt vmcnt(4)
    v_mfma_f32_16x16x32_bf16 v[32:35], v[24:27], v[120:123], v[32:35]
    buffer_load_dwordx4 v[76:79], v1, s[8:11], s16 offen offset:3072 nt
    s_add_u32 s16, s16, 0x4000
    s_waitcnt vmcnt(4)
    v_mfma_f32_16x16x32_bf16 v[32:35], v[28:31], v[124:127], v[32:35]
    buffer_load_dwordx4 v[80:83], v1, s[8:11], s16 offen offset:0 nt
    s_nop 7
    v_mov_b32_dpp v7, v32 quad_perm:[0,0,0,0] row_mask:0xf bank_mask:0xf
    v_mov_b32_dpp v8, v34 quad_perm:[2,2,2,2] row_mask:0xf bank_mask:0xf
    s_nop 0
    v_add_f32_dpp v7, v33, v7 quad_perm:[1,1,1,1] row_mask:0xf bank_mask:0xf
    v_add_f32_dpp v8, v35, v8 quad_perm:[3,3,3,3] row_mask:0xf bank_mask:0xf
    v_add_f32 v7, v7, v8
    v_cndmask_b32_e64 v6, v6, v7, s[52:53]
    v_cvt_pk_bf16_f32 v6, v6, v6
    v_and_b32 v6, 0xffff0000, v6
    v_mul_f32 v6, 0x3db504f3, v6
    v_cvt_pk_bf16_f32 v6, v6, v6
    v_and_b32 v6, 0xffff0000, v6
    v_max_f32 v5, v5, v6
    ds_write_b32 v3, v6
    v_add_u32 v3, 0x100, v3
    s_sub_u32 s19, s19, 1
    s_cmp_lg_u32 s19, 0
    s_cbranch_scc1 L_K_4
    s_waitcnt vmcnt(4)
    v_mfma_f32_16x16x32_bf16 v[32:35], v[16:19], v[64:67], 0
    buffer_load_dwordx4 v[84:87], v1, s[8:11], s16 offen offset:1024 nt
    s_waitcnt vmcnt(4)
    v_mfma_f32_16x16x32_bf16 v[32:35], v[20:23], v[68:71], v[32:35]
    buffer_load_dwordx4 v[88:91], v1, s[8:11], s16 offen offset:2048 nt
    s_waitcnt vmcnt(4)
    v_mfma_f32_16x16x32_bf16 v[32:35], v[24:27], v[72:75], v[32:35]
    buffer_load_dwordx4 v[92:95], v1, s[8:11], s16 offen offset:3072 nt
    s_add_u32 s16, s16, 0x4000
    s_waitcnt vmcnt(4)
    v_mfma_f32_16x16x32_bf16 v[32:35], v[28:31], v[76:79], v[32:35]
    buffer_load_dwordx4 v[96:99], v1, s[8:11], s16 offen offset:0 nt
    s_nop 7
    v_mov_b32_dpp v7, v32 quad_perm:[0,0,0,0] row_mask:0xf bank_mask:0xf
    v_mov_b32_dpp v8, v34 quad_perm:[2,2,2,2] row_mask:0xf bank_mask:0xf
    s_nop 0
    v_add_f32_dpp v7, v33, v7 quad_perm:[1,1,1,1] row_mask:0xf bank_mask:0xf
    v_add_f32_dpp v8, v35, v8 quad_perm:[3,3,3,3] row_mask:0xf bank_mask:0xf
    v_add_f32 v6, v7, v8
    s_waitcnt vmcnt(4)
    v_mfma_f32_16x16x32_bf16 v[32:35], v[16:19], v[80:83], 0
    buffer_load_dwordx4 v[100:103], v1, s[8:11], s16 offen offset:1024 nt
    s_waitcnt vmcnt(4)
    v_mfma_f32_16x16x32_bf16 v[32:35], v[20:23], v[84:87], v[32:35]
    buffer_load_dwordx4 v[104:107], v1, s[8:11], s16 offen offset:2048 nt
    s_waitcnt vmcnt(4)
    v_mfma_f32_16x16x32_bf16 v[32:35], v[24:27], v[88:91], v[32:35]
    buffer_load_dwordx4 v[108:111], v1, s[8:11], s16 offen offset:3072 nt
    s_add_u32 s16, s16, 0x4000
    s_waitcnt vmcnt(4)
    v_mfma_f32_16x16x32_bf16 v[32:35], v[28:31], v[92:95], v[32:35]
    buffer_load_dwordx4 v[112:115], v1, s[8:11], s16 offen offset:0 nt
    s_nop 7
    v_mov_b32_dpp v7, v32 quad_perm:[0,0,0,0] row_mask:0xf bank_mask:0xf
    v_mov_b32_dpp v8, v34 quad_perm:[2,2,2,2] row_mask:0xf bank_mask:0xf
    s_nop 0
    v_add_f32_dpp v7, v33, v7 quad_perm:[1,1,1,1] row_mask:0xf bank_mask:0xf
    v_add_f32_dpp v8, v35, v8 quad_perm:[3,3,3,3] row_mask:0xf bank_mask:0xf
    v_add_f32 v7, v7, v8
    v_cndmask_b32_e64 v6, v6, v7, s[48:49]
    s_waitcnt vmcnt(4)
    v_mfma_f32_16x16x32_bf16 v[32:35], v[16:19], v[96:99], 0
    buffer_load_dwordx4 v[116:119], v1, s[8:11], s16 offen offset:1024 nt
    s_waitcnt vmcnt(4)
    v_mfma_f32_16x16x32_bf16 v[32:35], v[20:23], v[100:103], v[32:35]
    buffer_load_dwordx4 v[120:123], v1, s[8:11], s16 offen offset:2048 nt
    s_waitcnt vmcnt(4)
    v_mfma_f32_16x16x32_bf16 v[32:35], v[24:27], v[104:107], v[32:35]
    buffer_load_dwordx4 v[124:127], v1, s[8:11], s16 offen offset:3072 nt
    s_add_u32 s16, s16, 0x4000
    s_waitcnt vmcnt(4)
    v_mfma_f32_16x16x32_bf16 v[32:35], v[28:31], v[108:111], v[32:35]
    buffer_load_dwordx4 v[64:67], v2, s[12:15], s17 offen offset:0 nt
    s_nop 7
    v_mov_b32_dpp v7, v32 quad_perm:[0,0,0,0] row_mask:0xf bank_mask:0xf
    v_mov_b32_dpp v8, v34 quad_perm:[2,2,2,2] row_mask:0xf bank_mask:0xf
    s_nop 0
    v_add_f32_dpp v7, v33, v7 quad_perm:[1,1,1,1] row_mask:0xf bank_mask:0xf
    v_add_f32_dpp v8, v35, v8 quad_perm:[3,3,3,3] row_mask:0xf bank_mask:0xf
    v_add_f32 v7, v7, v8
    v_cndmask_b32_e64 v6, v6, v7, s[50:51]
    s_waitcnt vmcnt(4)
    v_mfma_f32_16x16x32_bf16 v[32:35], v[16:19], v[112:115], 0
    buffer_load_dwordx4 v[68:71], v2, s[12:15], s17 offen offset:1024 nt
    s_waitcnt vmcnt(4)
    v_mfma_f32_16x16x32_bf16 v[32:35], v[20:23], v[116:119], v[32:35]
    buffer_load_dwordx4 v[72:75], v2, s[12:15], s17 offen offset:2048 nt
    s_waitcnt vmcnt(4)
    v_mfma_f32_16x16x32_bf16 v[32:35], v[24:27], v[120:123], v[32:35]
    buffer_load_dwordx4 v[76:79], v2, s[12:15], s17 offen offset:3072 nt
    s_add_u32 s17, s17, 0x4000
    s_waitcnt vmcnt(4)
    v_mfma_f32_16x16x32_bf16 v[32:35], v[28:31], v[124:127], v[32:35]
    buffer_load_dwordx4 v[80:83], v2, s[12:15], s17 offen offset:0 nt
    s_nop 7
    v_mov_b32_dpp v7, v32 quad_perm:[0,0,0,0] row_mask:0xf bank_mask:0xf
    v_mov_b32_dpp v8, v34 quad_perm:[2,2,2,2] row_mask:0xf bank_mask:0xf
    s_nop 0
    v_add_f32_dpp v7, v33, v7 quad_perm:[1,1,1,1] row_mask:0xf bank_mask:0xf
    v_add_f32_dpp v8, v35, v8 quad_perm:[3,3,3,3] row_mask:0xf bank_mask:0xf
    v_add_f32 v7, v7, v8
    v_cndmask_b32_e64 v6, v6, v7, s[52:53]
    v_cvt_pk_bf16_f32 v6, v6, v6
    v_and_b32 v6, 0xffff0000, v6
    v_mul_f32 v6, 0x3db504f3, v6
    v_cvt_pk_bf16_f32 v6, v6, v6
    v_and_b32 v6, 0xffff0000, v6
    v_max_f32 v5, v5, v6
    ds_write_b32 v3, v6
    v_add_u32 v3, 0x100, v3
    s_nop 1
    v_max_f32_dpp v5, v5, v5 row_ror:8 row_mask:0xf bank_mask:0xf
    s_nop 1
    v_max_f32_dpp v5, v5, v5 row_ror:4 row_mask:0xf bank_mask:0xf
    s_nop 1
    v_max_f32_dpp v5, v5, v5 row_ror:2 row_mask:0xf bank_mask:0xf
    s_nop 1
    v_max_f32_dpp v5, v5, v5 row_ror:1 row_mask:0xf bank_mask:0xf
    s_nop 1
    v_max_f32_dpp v5, v5, v5 row_bcast:15 row_mask:0xa bank_mask:0xf
    s_nop 1
    v_max_f32_dpp v5, v5, v5 row_bcast:31 row_mask:0xc bank_mask:0xf
    s_nop 1
    v_readlane_b32 s20, v5, 63
    s_nop 1
    v_mov_b32 v5, s20
    s_lshl_b32 s18, s3, 2
    s_add_u32 s18, s18, 2048
    v_mov_b32 v7, s18
    ds_write_b32 v7, v5
    ds_read_b32 v10, v4
    v_add_u32 v4, 0x100, v4
    v_mov_b32 v40, 0
    v_mov_b32 v41, 0
    v_mov_b32 v42, 0
    v_mov_b32 v43, 0
    v_and_b32 v7, 15, v0
    v_lshrrev_b32 v8, 4, v0
    v_and_b32 v8, 1, v8
    v_lshlrev_b32 v7, 5, v7
    v_lshlrev_b32 v8, 4, v8
    v_add_u32 v7, v7, v8
    s_lshl_b32 s18, s3, 9
    s_add_u32 s18, s18, 4096
    v_add_u32 v7, s18, v7
    s_mov_b32 s19, 16
    s_branch L_vc_5_top5
L_vc_5_top5:
    s_waitcnt lgkmcnt(0)
    v_sub_f32 v11, v10, v5
    v_mul_f32 v11, 0x3fb8aa3b, v11
    v_exp_f32 v11, v11
    ds_read_b32 v10, v4
    v_add_u32 v4, 0x100, v4
    v_cvt_pk_bf16_f32 v9, v11, v11
    s_nop 1
    v_and_b32_dpp v44, v9, v12 row_newbcast:0 row_mask:0xf bank_mask:0xf
    v_and_b32_dpp v45, v9, v13 row_newbcast:0 row_mask:0xf bank_mask:0xf
    v_and_b32_dpp v46, v9, v14 row_newbcast:0 row_mask:0xf bank_mask:0xf
    v_and_b32_dpp v47, v9, v15 row_newbcast:0 row_mask:0xf bank_mask:0xf
    s_waitcnt vmcnt(4)
    s_nop 0
    v_mfma_f32_16x16x32_bf16 v[40:43], v[44:47], v[64:67], v[40:43]
    buffer_load_dwordx4 v[84:87], v2, s[12:15], s17 offen offset:1024 nt
    v_and_b32_dpp v48, v9, v12 row_newbcast:4 row_mask:0xf bank_mask:0xf
    v_and_b32_dpp v49, v9, v13 row_newbcast:4 row_mask:0xf bank_mask:0xf
    v_and_b32_dpp v50, v9, v14 row_newbcast:4 row_mask:0xf bank_mask:0xf
    v_and_b32_dpp v51, v9, v15 row_newbcast:4 row_mask:0xf bank_mask:0xf
L_vc_5_s1_5:
    s_waitcnt vmcnt(4)
    s_nop 0
    v_mfma_f32_16x16x32_bf16 v[40:43], v[48:51], v[68:71], v[40:43]
    buffer_load_dwordx4 v[88:91], v2, s[12:15], s17 offen offset:2048 nt
    v_and_b32_dpp v44, v9, v12 row_newbcast:8 row_mask:0xf bank_mask:0xf
    v_and_b32_dpp v45, v9, v13 row_newbcast:8 row_mask:0xf bank_mask:0xf
    v_and_b32_dpp v46, v9, v14 row_newbcast:8 row_mask:0xf bank_mask:0xf
    v_and_b32_dpp v47, v9, v15 row_newbcast:8 row_mask:0xf bank_mask:0xf
    v_add_u32 v52, 2, v52
    ds_write_b32 v53, v52
    s_waitcnt vmcnt(4)
    s_nop 0
    v_mfma_f32_16x16x32_bf16 v[40:43], v[44:47], v[72:75], v[40:43]
    buffer_load_dwordx4 v[92:95], v2, s[12:15], s17 offen offset:3072 nt
    s_add_u32 s17, s17, 0x4000
    v_and_b32_dpp v48, v9, v12 row_newbcast:12 row_mask:0xf bank_mask:0xf
    v_and_b32_dpp v49, v9, v13 row_newbcast:12 row_mask:0xf bank_mask:0xf
    v_and_b32_dpp v50, v9, v14 row_newbcast:12 row_mask:0xf bank_mask:0xf
    v_and_b32_dpp v51, v9, v15 row_newbcast:12 row_mask:0xf bank_mask:0xf
    s_waitcnt vmcnt(4)
    s_nop 0
    v_mfma_f32_16x16x32_bf16 v[40:43], v[48:51], v[76:79], v[40:43]
    buffer_load_dwordx4 v[96:99], v2, s[12:15], s17 offen offset:0 nt
    v_and_b32_dpp v44, v9, v12 row_newbcast:1 row_mask:0xf bank_mask:0xf
    v_and_b32_dpp v45, v9, v13 row_newbcast:1 row_mask:0xf bank_mask:0xf
    v_and_b32_dpp v46, v9, v14 row_newbcast:1 row_mask:0xf bank_mask:0xf
    v_and_b32_dpp v47, v9, v15 row_newbcast:1 row_mask:0xf bank_mask:0xf
    v_add_u32 v52, 2, v52
    ds_write_b32 v53, v52
    s_waitcnt vmcnt(4)
    s_nop 0
    v_mfma_f32_16x16x32_bf16 v[40:43], v[44:47], v[80:83], v[40:43]
    buffer_load_dwordx4 v[100:103], v2, s[12:15], s17 offen offset:1024 nt
    v_and_b32_dpp v48, v9, v12 row_newbcast:5 row_mask:0xf bank_mask:0xf
    v_and_b32_dpp v49, v9, v13 row_newbcast:5 row_mask:0xf bank_mask:0xf
    v_and_b32_dpp v50, v9, v14 row_newbcast:5 row_mask:0xf bank_mask:0xf
    v_and_b32_dpp v51, v9, v15 row_newbcast:5 row_mask:0xf bank_mask:0xf
    s_waitcnt vmcnt(4)
    s_nop 0
    v_mfma_f32_16x16x32_bf16 v[40:43], v[48:51], v[84:87], v[40:43]
    buffer_load_dwordx4 v[104:107], v2, s[12:15], s17 offen offset:2048 nt
    v_and_b32_dpp v44, v9, v12 row_newbcast:9 row_mask:0xf bank_mask:0xf
    v_and_b32_dpp v45, v9, v13 row_newbcast:9 row_mask:0xf bank_mask:0xf
    v_and_b32_dpp v46, v9, v14 row_newbcast:9 row_mask:0xf bank_mask:0xf
    v_and_b32_dpp v47, v9, v15 row_newbcast:9 row_mask:0xf bank_mask:0xf
    v_add_u32 v52, 2, v52
    ds_write_b32 v53, v52
    s_waitcnt vmcnt(4)
    s_nop 0
    v_mfma_f32_16x16x32_bf16 v[40:43], v[44:47], v[88:91], v[40:43]
    buffer_load_dwordx4 v[108:111], v2, s[12:15], s17 offen offset:3072 nt
    s_add_u32 s17, s17, 0x4000
    v_and_b32_dpp v48, v9, v12 row_newbcast:13 row_mask:0xf bank_mask:0xf
    v_and_b32_dpp v49, v9, v13 row_newbcast:13 row_mask:0xf bank_mask:0xf
    v_and_b32_dpp v50, v9, v14 row_newbcast:13 row_mask:0xf bank_mask:0xf
    v_and_b32_dpp v51, v9, v15 row_newbcast:13 row_mask:0xf bank_mask:0xf
    s_waitcnt vmcnt(4)
    s_nop 0
    v_mfma_f32_16x16x32_bf16 v[40:43], v[48:51], v[92:95], v[40:43]
    buffer_load_dwordx4 v[112:115], v2, s[12:15], s17 offen offset:0 nt
    v_and_b32_dpp v44, v9, v12 row_newbcast:2 row_mask:0xf bank_mask:0xf
    v_and_b32_dpp v45, v9, v13 row_newbcast:2 row_mask:0xf bank_mask:0xf
    v_and_b32_dpp v46, v9, v14 row_newbcast:2 row_mask:0xf bank_mask:0xf
    v_and_b32_dpp v47, v9, v15 row_newbcast:2 row_mask:0xf bank_mask:0xf
    v_add_u32 v52, 2, v52
    ds_write_b32 v53, v52
    s_waitcnt vmcnt(4)
    s_nop 0
    v_mfma_f32_16x16x32_bf16 v[40:43], v[44:47], v[96:99], v[40:43]
    buffer_load_dwordx4 v[116:119], v2, s[12:15], s17 offen offset:1024 nt
    v_and_b32_dpp v48, v9, v12 row_newbcast:6 row_mask:0xf bank_mask:0xf
    v_and_b32_dpp v49, v9, v13 row_newbcast:6 row_mask:0xf bank_mask:0xf
    v_and_b32_dpp v50, v9, v14 row_newbcast:6 row_mask:0xf bank_mask:0xf
    v_and_b32_dpp v51, v9, v15 row_newbcast:6 row_mask:0xf bank_mask:0xf
    s_waitcnt vmcnt(4)
    s_nop 0
    v_mfma_f32_16x16x32_bf16 v[40:43], v[48:51], v[100:103], v[40:43]
    buffer_load_dwordx4 v[120:123], v2, s[12:15], s17 offen offset:2048 nt
    v_and_b32_dpp v44, v9, v12 row_newbcast:10 row_mask:0xf bank_mask:0xf
    v_and_b32_dpp v45, v9, v13 row_newbcast:10 row_mask:0xf bank_mask:0xf
    v_and_b32_dpp v46, v9, v14 row_newbcast:10 row_mask:0xf bank_mask:0xf
    v_and_b32_dpp v47, v9, v15 row_newbcast:10 row_mask:0xf bank_mask:0xf
    v_add_u32 v52, 2, v52
    ds_write_b32 v53, v52
    s_waitcnt vmcnt(4)
    s_nop 0
    v_mfma_f32_16x16x32_bf16 v[40:43], v[44:47], v[104:107], v[40:43]
    buffer_load_dwordx4 v[124:127], v2, s[12:15], s17 offen offset:3072 nt
    s_add_u32 s17, s17, 0x4000
    v_and_b32_dpp v48, v9, v12 row_newbcast:14 row_mask:0xf bank_mask:0xf
    v_and_b32_dpp v49, v9, v13 row_newbcast:14 row_mask:0xf bank_mask:0xf
    v_and_b32_dpp v50, v9, v14 row_newbcast:14 row_mask:0xf bank_mask:0xf
    v_and_b32_dpp v51, v9, v15 row_newbcast:14 row_mask:0xf bank_mask:0xf
    s_waitcnt vmcnt(4)
    s_nop 0
    v_mfma_f32_16x16x32_bf16 v[40:43], v[48:51], v[108:111], v[40:43]
    buffer_load_dwordx4 v[64:67], v2, s[12:15], s17 offen offset:0 nt
    v_and_b32_dpp v44, v9, v12 row_newbcast:3 row_mask:0xf bank_mask:0xf
    v_and_b32_dpp v45, v9, v13 row_newbcast:3 row_mask:0xf bank_mask:0xf
    v_and_b32_dpp v46, v9, v14 row_newbcast:3 row_mask:0xf bank_mask:0xf
    v_and_b32_dpp v47, v9, v15 row_newbcast:3 row_mask:0xf bank_mask:0xf
    v_add_u32 v52, 2, v52
    ds_write_b32 v53, v52
    s_waitcnt vmcnt(4)
    s_nop 0
    v_mfma_f32_16x16x32_bf16 v[40:43], v[44:47], v[112:115], v[40:43]
    buffer_load_dwordx4 v[68:71], v2, s[12:15], s17 offen offset:1024 nt
    v_and_b32_dpp v48, v9, v12 row_newbcast:7 row_mask:0xf bank_mask:0xf
    v_and_b32_dpp v49, v9, v13 row_newbcast:7 row_mask:0xf bank_mask:0xf
    v_and_b32_dpp v50, v9, v14 row_newbcast:7 row_mask:0xf bank_mask:0xf
    v_and_b32_dpp v51, v9, v15 row_newbcast:7 row_mask:0xf bank_mask:0xf
    s_waitcnt vmcnt(4)
    s_nop 0
    v_mfma_f32_16x16x32_bf16 v[40:43], v[48:51], v[116:119], v[40:43]
    buffer_load_dwordx4 v[72:75], v2, s[12:15], s17 offen offset:2048 nt
    v_and_b32_dpp v44, v9, v12 row_newbcast:11 row_mask:0xf bank_mask:0xf
    v_and_b32_dpp v45, v9, v13 row_newbcast:11 row_mask:0xf bank_mask:0xf
    v_and_b32_dpp v46, v9, v14 row_newbcast:11 row_mask:0xf bank_mask:0xf
    v_and_b32_dpp v47, v9, v15 row_newbcast:11 row_mask:0xf bank_mask:0xf
    v_add_u32 v52, 2, v52
    ds_write_b32 v53, v52
    ds_read_b32 v54, v55
    s_waitcnt vmcnt(4)
    s_nop 0
    v_mfma_f32_16x16x32_bf16 v[40:43], v[44:47], v[120:123], v[40:43]
    buffer_load_dwordx4 v[76:79], v2, s[12:15], s17 offen offset:3072 nt
    s_add_u32 s17, s17, 0x4000
    v_and_b32_dpp v48, v9, v12 row_newbcast:15 row_mask:0xf bank_mask:0xf
    v_and_b32_dpp v49, v9, v13 row_newbcast:15 row_mask:0xf bank_mask:0xf
    v_and_b32_dpp v50, v9, v14 row_newbcast:15 row_mask:0xf bank_mask:0xf
    v_and_b32_dpp v51, v9, v15 row_newbcast:15 row_mask:0xf bank_mask:0xf
    s_waitcnt vmcnt(4)
    s_nop 0
    v_mfma_f32_16x16x32_bf16 v[40:43], v[48:51], v[124:127], v[40:43]
    buffer_load_dwordx4 v[80:83], v2, s[12:15], s17 offen offset:0 nt
    v_add_u32 v52, 2, v52
    ds_write_b32 v53, v52
    s_sub_u32 s19, s19, 1
    s_cmp_eq_u32 s19, 0
    s_cbranch_scc1 L_vc_5_done
    s_waitcnt lgkmcnt(0)
    v_readfirstlane_b32 s21, v54
    s_cmp_gt_u32 s21, 5
    s_cbranch_scc1 L_vc_5_up5
    s_branch L_vc_5_top5
L_vc_5_up5:
    buffer_load_dwordx4 v[84:87], v2, s[12:15], s17 offen offset:1024 nt
    s_branch L_vc_5_top6
L_vc_5_top6:
    s_waitcnt lgkmcnt(0)
    v_sub_f32 v11, v10, v5
    v_mul_f32 v11, 0x3fb8aa3b, v11
    v_exp_f32 v11, v11
    ds_read_b32 v10, v4
    v_add_u32 v4, 0x100, v4
    v_cvt_pk_bf16_f32 v9, v11, v11
    s_nop 1
    v_and_b32_dpp v44, v9, v12 row_newbcast:0 row_mask:0xf bank_mask:0xf
    v_and_b32_dpp v45, v9, v13 row_newbcast:0 row_mask:0xf bank_mask:0xf
    v_and_b32_dpp v46, v9, v14 row_newbcast:0 row_mask:0xf bank_mask:0xf
    v_and_b32_dpp v47, v9, v15 row_newbcast:0 row_mask:0xf bank_mask:0xf
    s_waitcnt vmcnt(5)
    s_nop 0
    v_mfma_f32_16x16x32_bf16 v[40:43], v[44:47], v[64:67], v[40:43]
    buffer_load_dwordx4 v[88:91], v2, s[12:15], s17 offen offset:2048 nt
    v_and_b32_dpp v48, v9, v12 row_newbcast:4 row_mask:0xf bank_mask:0xf
    v_and_b32_dpp v49, v9, v13 row_newbcast:4 row_mask:0xf bank_mask:0xf
    v_and_b32_dpp v50, v9, v14 row_newbcast:4 row_mask:0xf bank_mask:0xf
    v_and_b32_dpp v51, v9, v15 row_newbcast:4 row_mask:0xf bank_mask:0xf
L_vc_5_s1_6:
    s_waitcnt vmcnt(5)
    s_nop 0
    v_mfma_f32_16x16x32_bf16 v[40:43], v[48:51], v[68:71], v[40:43]
    buffer_load_dwordx4 v[92:95], v2, s[12:15], s17 offen offset:3072 nt
    s_add_u32 s17, s17, 0x4000
    v_and_b32_dpp v44, v9, v12 row_newbcast:8 row_mask:0xf bank_mask:0xf
    v_and_b32_dpp v45, v9, v13 row_newbcast:8 row_mask:0xf bank_mask:0xf
    v_and_b32_dpp v46, v9, v14 row_newbcast:8 row_mask:0xf bank_mask:0xf
    v_and_b32_dpp v47, v9, v15 row_newbcast:8 row_mask:0xf bank_mask:0xf
    v_add_u32 v52, 2, v52
    ds_write_b32 v53, v52
    s_waitcnt vmcnt(5)
    s_nop 0
    v_mfma_f32_16x16x32_bf16 v[40:43], v[44:47], v[72:75], v[40:43]
    buffer_load_dwordx4 v[96:99], v2, s[12:15], s17 offen offset:0 nt
    v_and_b32_dpp v48, v9, v12 row_newbcast:12 row_mask:0xf bank_mask:0xf
    v_and_b32_dpp v49, v9, v13 row_newbcast:12 row_mask:0xf bank_mask:0xf
    v_and_b32_dpp v50, v9, v14 row_newbcast:12 row_mask:0xf bank_mask:0xf
    v_and_b32_dpp v51, v9, v15 row_newbcast:12 row_mask:0xf bank_mask:0xf
    s_waitcnt vmcnt(5)
    s_nop 0
    v_mfma_f32_16x16x32_bf16 v[40:43], v[48:51], v[76:79], v[40:43]
    buffer_load_dwordx4 v[100:103], v2, s[12:15], s17 offen offset:1024 nt
    v_and_b32_dpp v44, v9, v12 row_newbcast:1 row_mask:0xf bank_mask:0xf
    v_and_b32_dpp v45, v9, v13 row_newbcast:1 row_mask:0xf bank_mask:0xf
    v_and_b32_dpp v46, v9, v14 row_newbcast:1 row_mask:0xf bank_mask:0xf
    v_and_b32_dpp v47, v9, v15 row_newbcast:1 row_mask:0xf bank_mask:0xf
    v_add_u32 v52, 2, v52
    ds_write_b32 v53, v52
    s_waitcnt vmcnt(5)
    s_nop 0
    v_mfma_f32_16x16x32_bf16 v[40:43], v[44:47], v[80:83], v[40:43]
    buffer_load_dwordx4 v[104:107], v2, s[12:15], s17 offen offset:2048 nt
    v_and_b32_dpp v48, v9, v12 row_newbcast:5 row_mask:0xf bank_mask:0xf
    v_and_b32_dpp v49, v9, v13 row_newbcast:5 row_mask:0xf bank_mask:0xf
    v_and_b32_dpp v50, v9, v14 row_newbcast:5 row_mask:0xf bank_mask:0xf
    v_and_b32_dpp v51, v9, v15 row_newbcast:5 row_mask:0xf bank_mask:0xf
    s_waitcnt vmcnt(5)
    s_nop 0
    v_mfma_f32_16x16x32_bf16 v[40:43], v[48:51], v[84:87], v[40:43]
    buffer_load_dwordx4 v[108:111], v2, s[12:15], s17 offen offset:3072 nt
    s_add_u32 s17, s17, 0x4000
    v_and_b32_dpp v44, v9, v12 row_newbcast:9 row_mask:0xf bank_mask:0xf
    v_and_b32_dpp v45, v9, v13 row_newbcast:9 row_mask:0xf bank_mask:0xf
    v_and_b32_dpp v46, v9, v14 row_newbcast:9 row_mask:0xf bank_mask:0xf
    v_and_b32_dpp v47, v9, v15 row_newbcast:9 row_mask:0xf bank_mask:0xf
    v_add_u32 v52, 2, v52
    ds_write_b32 v53, v52
    s_waitcnt vmcnt(5)
    s_nop 0
    v_mfma_f32_16x16x32_bf16 v[40:43], v[44:47], v[88:91], v[40:43]
    buffer_load_dwordx4 v[112:115], v2, s[12:15], s17 offen offset:0 nt
    v_and_b32_dpp v48, v9, v12 row_newbcast:13 row_mask:0xf bank_mask:0xf
    v_and_b32_dpp v49, v9, v13 row_newbcast:13 row_mask:0xf bank_mask:0xf
    v_and_b32_dpp v50, v9, v14 row_newbcast:13 row_mask:0xf bank_mask:0xf
    v_and_b32_dpp v51, v9, v15 row_newbcast:13 row_mask:0xf bank_mask:0xf
    s_waitcnt vmcnt(5)
    s_nop 0
    v_mfma_f32_16x16x32_bf16 v[40:43], v[48:51], v[92:95], v[40:43]
    buffer_load_dwordx4 v[116:119], v2, s[12:15], s17 offen offset:1024 nt
    v_and_b32_dpp v44, v9, v12 row_newbcast:2 row_mask:0xf bank_mask:0xf
    v_and_b32_dpp v45, v9, v13 row_newbcast:2 row_mask:0xf bank_mask:0xf
    v_and_b32_dpp v46, v9, v14 row_newbcast:2 row_mask:0xf bank_mask:0xf
    v_and_b32_dpp v47, v9, v15 row_newbcast:2 row_mask:0xf bank_mask:0xf
    v_add_u32 v52, 2, v52
    ds_write_b32 v53, v52
    s_waitcnt vmcnt(5)
    s_nop 0
    v_mfma_f32_16x16x32_bf16 v[40:43], v[44:47], v[96:99], v[40:43]
    buffer_load_dwordx4 v[120:123], v2, s[12:15], s17 offen offset:2048 nt
    v_and_b32_dpp v48, v9, v12 row_newbcast:6 row_mask:0xf bank_mask:0xf
    v_and_b32_dpp v49, v9, v13 row_newbcast:6 row_mask:0xf bank_mask:0xf
    v_and_b32_dpp v50, v9, v14 row_newbcast:6 row_mask:0xf bank_mask:0xf
    v_and_b32_dpp v51, v9, v15 row_newbcast:6 row_mask:0xf bank_mask:0xf
    s_waitcnt vmcnt(5)
    s_nop 0
    v_mfma_f32_16x16x32_bf16 v[40:43], v[48:51], v[100:103], v[40:43]
    buffer_load_dwordx4 v[124:127], v2, s[12:15], s17 offen offset:3072 nt
    s_add_u32 s17, s17, 0x4000
    v_and_b32_dpp v44, v9, v12 row_newbcast:10 row_mask:0xf bank_mask:0xf
    v_and_b32_dpp v45, v9, v13 row_newbcast:10 row_mask:0xf bank_mask:0xf
    v_and_b32_dpp v46, v9, v14 row_newbcast:10 row_mask:0xf bank_mask:0xf
    v_and_b32_dpp v47, v9, v15 row_newbcast:10 row_mask:0xf bank_mask:0xf
    v_add_u32 v52, 2, v52
    ds_write_b32 v53, v52
    s_waitcnt vmcnt(5)
    s_nop 0
    v_mfma_f32_16x16x32_bf16 v[40:43], v[44:47], v[104:107], v[40:43]
    buffer_load_dwordx4 v[64:67], v2, s[12:15], s17 offen offset:0 nt
    v_and_b32_dpp v48, v9, v12 row_newbcast:14 row_mask:0xf bank_mask:0xf
    v_and_b32_dpp v49, v9, v13 row_newbcast:14 row_mask:0xf bank_mask:0xf
    v_and_b32_dpp v50, v9, v14 row_newbcast:14 row_mask:0xf bank_mask:0xf
    v_and_b32_dpp v51, v9, v15 row_newbcast:14 row_mask:0xf bank_mask:0xf
    s_waitcnt vmcnt(5)
    s_nop 0
    v_mfma_f32_16x16x32_bf16 v[40:43], v[48:51], v[108:111], v[40:43]
    buffer_load_dwordx4 v[68:71], v2, s[12:15], s17 offen offset:1024 nt
    v_and_b32_dpp v44, v9, v12 row_newbcast:3 row_mask:0xf bank_mask:0xf
    v_and_b32_dpp v45, v9, v13 row_newbcast:3 row_mask:0xf bank_mask:0xf
    v_and_b32_dpp v46, v9, v14 row_newbcast:3 row_mask:0xf bank_mask:0xf
    v_and_b32_dpp v47, v9, v15 row_newbcast:3 row_mask:0xf bank_mask:0xf
    v_add_u32 v52, 2, v52
    ds_write_b32 v53, v52
    s_waitcnt vmcnt(5)
    s_nop 0
    v_mfma_f32_16x16x32_bf16 v[40:43], v[44:47], v[112:115], v[40:43]
    buffer_load_dwordx4 v[72:75], v2, s[12:15], s17 offen offset:2048 nt
    v_and_b32_dpp v48, v9, v12 row_newbcast:7 row_mask:0xf bank_mask:0xf
    v_and_b32_dpp v49, v9, v13 row_newbcast:7 row_mask:0xf bank_mask:0xf
    v_and_b32_dpp v50, v9, v14 row_newbcast:7 row_mask:0xf bank_mask:0xf
    v_and_b32_dpp v51, v9, v15 row_newbcast:7 row_mask:0xf bank_mask:0xf
    s_waitcnt vmcnt(5)
    s_nop 0
    v_mfma_f32_16x16x32_bf16 v[40:43], v[48:51], v[116:119], v[40:43]
    buffer_load_dwordx4 v[76:79], v2, s[12:15], s17 offen offset:3072 nt
    s_add_u32 s17, s17, 0x4000
    v_and_b32_dpp v44, v9, v12 row_newbcast:11 row_mask:0xf bank_mask:0xf
    v_and_b32_dpp v45, v9, v13 row_newbcast:11 row_mask:0xf bank_mask:0xf
    v_and_b32_dpp v46, v9, v14 row_newbcast:11 row_mask:0xf bank_mask:0xf
    v_and_b32_dpp v47, v9, v15 row_newbcast:11 row_mask:0xf bank_mask:0xf
    v_add_u32 v52, 2, v52
    ds_write_b32 v53, v52
    ds_read_b32 v54, v55
    s_waitcnt vmcnt(5)
    s_nop 0
    v_mfma_f32_16x16x32_bf16 v[40:43], v[44:47], v[120:123], v[40:43]
    buffer_load_dwordx4 v[80:83], v2, s[12:15], s17 offen offset:0 nt
    v_and_b32_dpp v48, v9, v12 row_newbcast:15 row_mask:0xf bank_mask:0xf
    v_and_b32_dpp v49, v9, v13 row_newbcast:15 row_mask:0xf bank_mask:0xf
    v_and_b32_dpp v50, v9, v14 row_newbcast:15 row_mask:0xf bank_mask:0xf
    v_and_b32_dpp v51, v9, v15 row_newbcast:15 row_mask:0xf bank_mask:0xf
    s_waitcnt vmcnt(5)
    s_nop 0
    v_mfma_f32_16x16x32_bf16 v[40:43], v[48:51], v[124:127], v[40:43]
    buffer_load_dwordx4 v[84:87], v2, s[12:15], s17 offen offset:1024 nt
    v_add_u32 v52, 2, v52
    ds_write_b32 v53, v52
    s_sub_u32 s19, s19, 1
    s_cmp_eq_u32 s19, 0
    s_cbranch_scc1 L_vc_5_done
    s_waitcnt lgkmcnt(0)
    v_readfirstlane_b32 s21, v54
    s_cmp_gt_u32 s21, 6
    s_cbranch_scc1 L_vc_5_up6
    s_cmp_lt_u32 s21, 6
    s_cbranch_scc1 L_vc_5_dn6
    s_branch L_vc_5_top6
L_vc_5_up6:
    buffer_load_dwordx4 v[88:91], v2, s[12:15], s17 offen offset:2048 nt
    s_branch L_vc_5_top7
L_vc_5_dn6:
    s_waitcnt lgkmcnt(0)
    v_sub_f32 v11, v10, v5
    v_mul_f32 v11, 0x3fb8aa3b, v11
    v_exp_f32 v11, v11
    ds_read_b32 v10, v4
    v_add_u32 v4, 0x100, v4
    v_cvt_pk_bf16_f32 v9, v11, v11
    s_nop 1
    v_and_b32_dpp v44, v9, v12 row_newbcast:0 row_mask:0xf bank_mask:0xf
    v_and_b32_dpp v45, v9, v13 row_newbcast:0 row_mask:0xf bank_mask:0xf
    v_and_b32_dpp v46, v9, v14 row_newbcast:0 row_mask:0xf bank_mask:0xf
    v_and_b32_dpp v47, v9, v15 row_newbcast:0 row_mask:0xf bank_mask:0xf
    s_waitcnt vmcnt(5)
    s_nop 0
    v_mfma_f32_16x16x32_bf16 v[40:43], v[44:47], v[64:67], v[40:43]
    v_and_b32_dpp v48, v9, v12 row_newbcast:4 row_mask:0xf bank_mask:0xf
    v_and_b32_dpp v49, v9, v13 row_newbcast:4 row_mask:0xf bank_mask:0xf
    v_and_b32_dpp v50, v9, v14 row_newbcast:4 row_mask:0xf bank_mask:0xf
    v_and_b32_dpp v51, v9, v15 row_newbcast:4 row_mask:0xf bank_mask:0xf
    s_branch L_vc_5_s1_5
L_vc_5_top7:
    s_waitcnt lgkmcnt(0)
    v_sub_f32 v11, v10, v5
    v_mul_f32 v11, 0x3fb8aa3b, v11
    v_exp_f32 v11, v11
    ds_read_b32 v10, v4
    v_add_u32 v4, 0x100, v4
    v_cvt_pk_bf16_f32 v9, v11, v11
    s_nop 1
    v_and_b32_dpp v44, v9, v12 row_newbcast:0 row_mask:0xf bank_mask:0xf
    v_and_b32_dpp v45, v9, v13 row_newbcast:0 row_mask:0xf bank_mask:0xf
    v_and_b32_dpp v46, v9, v14 row_newbcast:0 row_mask:0xf bank_mask:0xf
    v_and_b32_dpp v47, v9, v15 row_newbcast:0 row_mask:0xf bank_mask:0xf
    s_waitcnt vmcnt(6)
    s_nop 0
    v_mfma_f32_16x16x32_bf16 v[40:43], v[44:47], v[64:67], v[40:43]
    buffer_load_dwordx4 v[92:95], v2, s[12:15], s17 offen offset:3072 nt
    s_add_u32 s17, s17, 0x4000
    v_and_b32_dpp v48, v9, v12 row_newbcast:4 row_mask:0xf bank_mask:0xf
    v_and_b32_dpp v49, v9, v13 row_newbcast:4 row_mask:0xf bank_mask:0xf
    v_and_b32_dpp v50, v9, v14 row_newbcast:4 row_mask:0xf bank_mask:0xf
    v_and_b32_dpp v51, v9, v15 row_newbcast:4 row_mask:0xf bank_mask:0xf
L_vc_5_s1_7:
    s_waitcnt vmcnt(6)
    s_nop 0
    v_mfma_f32_16x16x32_bf16 v[40:43], v[48:51], v[68:71], v[40:43]
    buffer_load_dwordx4 v[96:99], v2, s[12:15], s17 offen offset:0 nt
    v_and_b32_dpp v44, v9, v12 row_newbcast:8 row_mask:0xf bank_mask:0xf
    v_and_b32_dpp v45, v9, v13 row_newbcast:8 row_mask:0xf bank_mask:0xf
    v_and_b32_dpp v46, v9, v14 row_newbcast:8 row_mask:0xf bank_mask:0xf
    v_and_b32_dpp v47, v9, v15 row_newbcast:8 row_mask:0xf bank_mask:0xf
    v_add_u32 v52, 2, v52
    ds_write_b32 v53, v52
    s_waitcnt vmcnt(6)
    s_nop 0
    v_mfma_f32_16x16x32_bf16 v[40:43], v[44:47], v[72:75], v[40:43]
    buffer_load_dwordx4 v[100:103], v2, s[12:15], s17 offen offset:1024 nt
    v_and_b32_dpp v48, v9, v12 row_newbcast:12 row_mask:0xf bank_mask:0xf
    v_and_b32_dpp v49, v9, v13 row_newbcast:12 row_mask:0xf bank_mask:0xf
    v_and_b32_dpp v50, v9, v14 row_newbcast:12 row_mask:0xf bank_mask:0xf
    v_and_b32_dpp v51, v9, v15 row_newbcast:12 row_mask:0xf bank_mask:0xf
    s_waitcnt vmcnt(6)
    s_nop 0
    v_mfma_f32_16x16x32_bf16 v[40:43], v[48:51], v[76:79], v[40:43]
    buffer_load_dwordx4 v[104:107], v2, s[12:15], s17 offen offset:2048 nt
    v_and_b32_dpp v44, v9, v12 row_newbcast:1 row_mask:0xf bank_mask:0xf
    v_and_b32_dpp v45, v9, v13 row_newbcast:1 row_mask:0xf bank_mask:0xf
    v_and_b32_dpp v46, v9, v14 row_newbcast:1 row_mask:0xf bank_mask:0xf
    v_and_b32_dpp v47, v9, v15 row_newbcast:1 row_mask:0xf bank_mask:0xf
    v_add_u32 v52, 2, v52
    ds_write_b32 v53, v52
    s_waitcnt vmcnt(6)
    s_nop 0
    v_mfma_f32_16x16x32_bf16 v[40:43], v[44:47], v[80:83], v[40:43]
    buffer_load_dwordx4 v[108:111], v2, s[12:15], s17 offen offset:3072 nt
    s_add_u32 s17, s17, 0x4000
    v_and_b32_dpp v48, v9, v12 row_newbcast:5 row_mask:0xf bank_mask:0xf
    v_and_b32_dpp v49, v9, v13 row_newbcast:5 row_mask:0xf bank_mask:0xf
    v_and_b32_dpp v50, v9, v14 row_newbcast:5 row_mask:0xf bank_mask:0xf
    v_and_b32_dpp v51, v9, v15 row_newbcast:5 row_mask:0xf bank_mask:0xf
    s_waitcnt vmcnt(6)
    s_nop 0
    v_mfma_f32_16x16x32_bf16 v[40:43], v[48:51], v[84:87], v[40:43]
    buffer_load_dwordx4 v[112:115], v2, s[12:15], s17 offen offset:0 nt
    v_and_b32_dpp v44, v9, v12 row_newbcast:9 row_mask:0xf bank_mask:0xf
    v_and_b32_dpp v45, v9, v13 row_newbcast:9 row_mask:0xf bank_mask:0xf
    v_and_b32_dpp v46, v9, v14 row_newbcast:9 row_mask:0xf bank_mask:0xf
    v_and_b32_dpp v47, v9, v15 row_newbcast:9 row_mask:0xf bank_mask:0xf
    v_add_u32 v52, 2, v52
    ds_write_b32 v53, v52
    s_waitcnt vmcnt(6)
    s_nop 0
    v_mfma_f32_16x16x32_bf16 v[40:43], v[44:47], v[88:91], v[40:43]
    buffer_load_dwordx4 v[116:119], v2, s[12:15], s17 offen offset:1024 nt
    v_and_b32_dpp v48, v9, v12 row_newbcast:13 row_mask:0xf bank_mask:0xf
    v_and_b32_dpp v49, v9, v13 row_newbcast:13 row_mask:0xf bank_mask:0xf
    v_and_b32_dpp v50, v9, v14 row_newbcast:13 row_mask:0xf bank_mask:0xf
    v_and_b32_dpp v51, v9, v15 row_newbcast:13 row_mask:0xf bank_mask:0xf
    s_waitcnt vmcnt(6)
    s_nop 0
    v_mfma_f32_16x16x32_bf16 v[40:43], v[48:51], v[92:95], v[40:43]
    buffer_load_dwordx4 v[120:123], v2, s[12:15], s17 offen offset:2048 nt
    v_and_b32_dpp v44, v9, v12 row_newbcast:2 row_mask:0xf bank_mask:0xf
    v_and_b32_dpp v45, v9, v13 row_newbcast:2 row_mask:0xf bank_mask:0xf
    v_and_b32_dpp v46, v9, v14 row_newbcast:2 row_mask:0xf bank_mask:0xf
    v_and_b32_dpp v47, v9, v15 row_newbcast:2 row_mask:0xf bank_mask:0xf
    v_add_u32 v52, 2, v52
    ds_write_b32 v53, v52
    s_waitcnt vmcnt(6)
    s_nop 0
    v_mfma_f32_16x16x32_bf16 v[40:43], v[44:47], v[96:99], v[40:43]
    buffer_load_dwordx4 v[124:127], v2, s[12:15], s17 offen offset:3072 nt
    s_add_u32 s17, s17, 0x4000
    v_and_b32_dpp v48, v9, v12 row_newbcast:6 row_mask:0xf bank_mask:0xf
    v_and_b32_dpp v49, v9, v13 row_newbcast:6 row_mask:0xf bank_mask:0xf
    v_and_b32_dpp v50, v9, v14 row_newbcast:6 row_mask:0xf bank_mask:0xf
    v_and_b32_dpp v51, v9, v15 row_newbcast:6 row_mask:0xf bank_mask:0xf
    s_waitcnt vmcnt(6)
    s_nop 0
    v_mfma_f32_16x16x32_bf16 v[40:43], v[48:51], v[100:103], v[40:43]
    buffer_load_dwordx4 v[64:67], v2, s[12:15], s17 offen offset:0 nt
    v_and_b32_dpp v44, v9, v12 row_newbcast:10 row_mask:0xf bank_mask:0xf
    v_and_b32_dpp v45, v9, v13 row_newbcast:10 row_mask:0xf bank_mask:0xf
    v_and_b32_dpp v46, v9, v14 row_newbcast:10 row_mask:0xf bank_mask:0xf
    v_and_b32_dpp v47, v9, v15 row_newbcast:10 row_mask:0xf bank_mask:0xf
    v_add_u32 v52, 2, v52
    ds_write_b32 v53, v52
    s_waitcnt vmcnt(6)
    s_nop 0
    v_mfma_f32_16x16x32_bf16 v[40:43], v[44:47], v[104:107], v[40:43]
    buffer_load_dwordx4 v[68:71], v2, s[12:15], s17 offen offset:1024 nt
    v_and_b32_dpp v48, v9, v12 row_newbcast:14 row_mask:0xf bank_mask:0xf
    v_and_b32_dpp v49, v9, v13 row_newbcast:14 row_mask:0xf bank_mask:0xf
    v_and_b32_dpp v50, v9, v14 row_newbcast:14 row_mask:0xf bank_mask:0xf
    v_and_b32_dpp v51, v9, v15 row_newbcast:14 row_mask:0xf bank_mask:0xf
    s_waitcnt vmcnt(6)
    s_nop 0
    v_mfma_f32_16x16x32_bf16 v[40:43], v[48:51], v[108:111], v[40:43]
    buffer_load_dwordx4 v[72:75], v2, s[12:15], s17 offen offset:2048 nt
    v_and_b32_dpp v44, v9, v12 row_newbcast:3 row_mask:0xf bank_mask:0xf
    v_and_b32_dpp v45, v9, v13 row_newbcast:3 row_mask:0xf bank_mask:0xf
    v_and_b32_dpp v46, v9, v14 row_newbcast:3 row_mask:0xf bank_mask:0xf
    v_and_b32_dpp v47, v9, v15 row_newbcast:3 row_mask:0xf bank_mask:0xf
    v_add_u32 v52, 2, v52
    ds_write_b32 v53, v52
    s_waitcnt vmcnt(6)
    s_nop 0
    v_mfma_f32_16x16x32_bf16 v[40:43], v[44:47], v[112:115], v[40:43]
    buffer_load_dwordx4 v[76:79], v2, s[12:15], s17 offen offset:3072 nt
    s_add_u32 s17, s17, 0x4000
    v_and_b32_dpp v48, v9, v12 row_newbcast:7 row_mask:0xf bank_mask:0xf
    v_and_b32_dpp v49, v9, v13 row_newbcast:7 row_mask:0xf bank_mask:0xf
    v_and_b32_dpp v50, v9, v14 row_newbcast:7 row_mask:0xf bank_mask:0xf
    v_and_b32_dpp v51, v9, v15 row_newbcast:7 row_mask:0xf bank_mask:0xf
    s_waitcnt vmcnt(6)
    s_nop 0
    v_mfma_f32_16x16x32_bf16 v[40:43], v[48:51], v[116:119], v[40:43]
    buffer_load_dwordx4 v[80:83], v2, s[12:15], s17 offen offset:0 nt
    v_and_b32_dpp v44, v9, v12 row_newbcast:11 row_mask:0xf bank_mask:0xf
    v_and_b32_dpp v45, v9, v13 row_newbcast:11 row_mask:0xf bank_mask:0xf
    v_and_b32_dpp v46, v9, v14 row_newbcast:11 row_mask:0xf bank_mask:0xf
    v_and_b32_dpp v47, v9, v15 row_newbcast:11 row_mask:0xf bank_mask:0xf
    v_add_u32 v52, 2, v52
    ds_write_b32 v53, v52
    ds_read_b32 v54, v55
    s_waitcnt vmcnt(6)
    s_nop 0
    v_mfma_f32_16x16x32_bf16 v[40:43], v[44:47], v[120:123], v[40:43]
    buffer_load_dwordx4 v[84:87], v2, s[12:15], s17 offen offset:1024 nt
    v_and_b32_dpp v48, v9, v12 row_newbcast:15 row_mask:0xf bank_mask:0xf
    v_and_b32_dpp v49, v9, v13 row_newbcast:15 row_mask:0xf bank_mask:0xf
    v_and_b32_dpp v50, v9, v14 row_newbcast:15 row_mask:0xf bank_mask:0xf
    v_and_b32_dpp v51, v9, v15 row_newbcast:15 row_mask:0xf bank_mask:0xf
    s_waitcnt vmcnt(6)
    s_nop 0
    v_mfma_f32_16x16x32_bf16 v[40:43], v[48:51], v[124:127], v[40:43]
    buffer_load_dwordx4 v[88:91], v2, s[12:15], s17 offen offset:2048 nt
    v_add_u32 v52, 2, v52
    ds_write_b32 v53, v52
    s_sub_u32 s19, s19, 1
    s_cmp_eq_u32 s19, 0
    s_cbranch_scc1 L_vc_5_done
    s_waitcnt lgkmcnt(0)
    v_readfirstlane_b32 s21, v54
    s_cmp_lt_u32 s21, 7
    s_cbranch_scc1 L_vc_5_dn7
    s_branch L_vc_5_top7
L_vc_5_dn7:
    s_waitcnt lgkmcnt(0)
    v_sub_f32 v11, v10, v5
    v_mul_f32 v11, 0x3fb8aa3b, v11
    v_exp_f32 v11, v11
    ds_read_b32 v10, v4
    v_add_u32 v4, 0x100, v4
    v_cvt_pk_bf16_f32 v9, v11, v11
    s_nop 1
    v_and_b32_dpp v44, v9, v12 row_newbcast:0 row_mask:0xf bank_mask:0xf
    v_and_b32_dpp v45, v9, v13 row_newbcast:0 row_mask:0xf bank_mask:0xf
    v_and_b32_dpp v46, v9, v14 row_newbcast:0 row_mask:0xf bank_mask:0xf
    v_and_b32_dpp v47, v9, v15 row_newbcast:0 row_mask:0xf bank_mask:0xf
    s_waitcnt vmcnt(6)
    s_nop 0
    v_mfma_f32_16x16x32_bf16 v[40:43], v[44:47], v[64:67], v[40:43]
    v_and_b32_dpp v48, v9, v12 row_newbcast:4 row_mask:0xf bank_mask:0xf
    v_and_b32_dpp v49, v9, v13 row_newbcast:4 row_mask:0xf bank_mask:0xf
    v_and_b32_dpp v50, v9, v14 row_newbcast:4 row_mask:0xf bank_mask:0xf
    v_and_b32_dpp v51, v9, v15 row_newbcast:4 row_mask:0xf bank_mask:0xf
    s_branch L_vc_5_s1_6
L_vc_5_done:
    s_nop 7
    ds_write_b128 v7, v[40:43]
    s_waitcnt lgkmcnt(0)
    s_barrier
    s_endpgm
L_helper:
    s_sub_u32 s5, s3, 4
    v_and_b32 v1, 15, v0
    v_lshrrev_b32 v2, 4, v0
    s_mul_i32 s48, s5, 40
    s_lshl_b32 s52, s44, 1
    s_add_u32 s52, s52, s46
    s_mul_i32 s52, s52, 5
    s_mul_i32 s49, s44, 1280
    v_lshlrev_b32 v3, 13, v2
    v_lshlrev_b32 v9, 4, v1
    v_add_u32 v3, v3, v9
    s_mul_i32 s53, s5, 1310720
    s_lshl_b32 s51, s45, 8
    s_add_u32 s53, s53, s51
    s_lshl_b32 s50, s52, 15
    s_add_u32 s50, s50, s53
    s_add_u32 s51, s53, 1310720
    s_waitcnt lgkmcnt(0)
    s_mov_b32 s8, s64
    s_mov_b32 s9, s65
    s_mov_b32 s10, 0x1400
    s_mov_b32 s11, 0x20000
    s_mov_b32 s12, s70
    s_mov_b32 s13, s71
    s_mov_b32 s14, 0x500000
    s_mov_b32 s15, 0x20000
    v_add_u32 v52, 0, v1
    v_add_u32 v8, s52, v52
    v_subrev_u32 v9, 40, v8
    v_min_u32 v8, v8, v9
    v_add_u32 v8, s48, v8
    v_mov_b32 v52, v8
    v_lshlrev_b32 v52, 2, v52
    v_add_u32 v52, v52, v2
    v_lshlrev_b32 v52, 1, v52
    buffer_load_ushort v10, v52, s[8:11], s49 offen
    v_add_u32 v53, 16, v1
    v_add_u32 v8, s52, v53
    v_subrev_u32 v9, 40, v8
    v_min_u32 v8, v8, v9
    v_add_u32 v8, s48, v8
    v_mov_b32 v53, v8
    v_lshlrev_b32 v53, 2, v53
    v_add_u32 v53, v53, v2
    v_lshlrev_b32 v53, 1, v53
    buffer_load_ushort v11, v53, s[8:11], s49 offen
    v_add_u32 v54, 32, v1
    v_add_u32 v8, s52, v54
    v_subrev_u32 v9, 40, v8
    v_min_u32 v8, v8, v9
    v_add_u32 v8, s48, v8
    v_add_u32 v54, s48, v54
    v_subrev_u32 v9, 160, v54
    v_min_u32 v54, v54, v9
    v_cmp_gt_u32 vcc, 8, v1
    s_nop 1
    v_cndmask_b32 v54, v54, v8, vcc
    v_lshlrev_b32 v54, 2, v54
    v_add_u32 v54, v54, v2
    v_lshlrev_b32 v54, 1, v54
    buffer_load_ushort v12, v54, s[8:11], s49 offen
    v_add_u32 v55, 48, v1
    v_add_u32 v55, s48, v55
    v_subrev_u32 v9, 160, v55
    v_min_u32 v55, v55, v9
    v_lshlrev_b32 v55, 2, v55
    v_add_u32 v55, v55, v2
    v_lshlrev_b32 v55, 1, v55
    buffer_load_ushort v13, v55, s[8:11], s49 offen
    v_add_u32 v52, 64, v1
    v_add_u32 v52, s48, v52
    v_subrev_u32 v9, 160, v52
    v_min_u32 v52, v52, v9
    v_lshlrev_b32 v52, 2, v52
    v_add_u32 v52, v52, v2
    v_lshlrev_b32 v52, 1, v52
    buffer_load_ushort v14, v52, s[8:11], s49 offen
    v_add_u32 v53, 80, v1
    v_add_u32 v53, s48, v53
    v_subrev_u32 v9, 160, v53
    v_min_u32 v53, v53, v9
    v_lshlrev_b32 v53, 2, v53
    v_add_u32 v53, v53, v2
    v_lshlrev_b32 v53, 1, v53
    buffer_load_ushort v15, v53, s[8:11], s49 offen
    v_add_u32 v54, 96, v1
    v_add_u32 v54, s48, v54
    v_subrev_u32 v9, 160, v54
    v_min_u32 v54, v54, v9
    v_lshlrev_b32 v54, 2, v54
    v_add_u32 v54, v54, v2
    v_lshlrev_b32 v54, 1, v54
    buffer_load_ushort v16, v54, s[8:11], s49 offen
    v_add_u32 v55, 112, v1
    v_add_u32 v55, s48, v55
    v_subrev_u32 v9, 160, v55
    v_min_u32 v55, v55, v9
    v_lshlrev_b32 v55, 2, v55
    v_add_u32 v55, v55, v2
    v_lshlrev_b32 v55, 1, v55
    buffer_load_ushort v17, v55, s[8:11], s49 offen
    v_add_u32 v52, 128, v1
    v_add_u32 v52, s48, v52
    v_subrev_u32 v9, 160, v52
    v_min_u32 v52, v52, v9
    v_lshlrev_b32 v52, 2, v52
    v_add_u32 v52, v52, v2
    v_lshlrev_b32 v52, 1, v52
    buffer_load_ushort v18, v52, s[8:11], s49 offen
    v_add_u32 v53, 144, v1
    v_add_u32 v53, s48, v53
    v_subrev_u32 v9, 160, v53
    v_min_u32 v53, v53, v9
    v_lshlrev_b32 v53, 2, v53
    v_add_u32 v53, v53, v2
    v_lshlrev_b32 v53, 1, v53
    buffer_load_ushort v19, v53, s[8:11], s49 offen
    buffer_load_dwordx4 v[64:67], v3, s[12:15], s50 offen nt
    s_add_u32 s50, s50, 0x8000
    s_cmp_eq_u32 s50, s51
    s_cselect_b32 s50, s53, s50
    buffer_load_dwordx4 v[68:71], v3, s[12:15], s50 offen nt
    s_add_u32 s50, s50, 0x8000
    s_cmp_eq_u32 s50, s51
    s_cselect_b32 s50, s53, s50
    buffer_load_dwordx4 v[72:75], v3, s[12:15], s50 offen nt
    s_add_u32 s50, s50, 0x8000
    s_cmp_eq_u32 s50, s51
    s_cselect_b32 s50, s53, s50
    buffer_load_dwordx4 v[76:79], v3, s[12:15], s50 offen nt
    s_add_u32 s50, s50, 0x8000
    s_cmp_eq_u32 s50, s51
    s_cselect_b32 s50, s53, s50
    buffer_load_dwordx4 v[80:83], v3, s[12:15], s50 offen nt
    s_add_u32 s50, s50, 0x8000
    s_cmp_eq_u32 s50, s51
    s_cselect_b32 s50, s53, s50
    buffer_load_dwordx4 v[84:87], v3, s[12:15], s50 offen nt
    s_add_u32 s50, s50, 0x8000
    s_cmp_eq_u32 s50, s51
    s_cselect_b32 s50, s53, s50
    buffer_load_dwordx4 v[88:91], v3, s[12:15], s50 offen nt
    s_add_u32 s50, s50, 0x8000
    s_cmp_eq_u32 s50, s51
    s_cselect_b32 s50, s53, s50
    buffer_load_dwordx4 v[92:95], v3, s[12:15], s50 offen nt
    s_add_u32 s50, s50, 0x8000
    s_cmp_eq_u32 s50, s51
    s_cselect_b32 s50, s53, s50
    buffer_load_dwordx4 v[96:99], v3, s[12:15], s50 offen nt
    s_add_u32 s50, s50, 0x8000
    s_cmp_eq_u32 s50, s51
    s_cselect_b32 s50, s53, s50
    buffer_load_dwordx4 v[100:103], v3, s[12:15], s50 offen nt
    s_add_u32 s50, s50, 0x8000
    s_cmp_eq_u32 s50, s51
    s_cselect_b32 s50, s53, s50
    buffer_load_dwordx4 v[104:107], v3, s[12:15], s50 offen nt
    s_add_u32 s50, s50, 0x8000
    s_cmp_eq_u32 s50, s51
    s_cselect_b32 s50, s53, s50
    buffer_load_dwordx4 v[108:111], v3, s[12:15], s50 offen nt
    s_add_u32 s50, s50, 0x8000
    s_cmp_eq_u32 s50, s51
    s_cselect_b32 s50, s53, s50
    buffer_load_dwordx4 v[112:115], v3, s[12:15], s50 offen nt
    s_add_u32 s50, s50, 0x8000
    s_cmp_eq_u32 s50, s51
    s_cselect_b32 s50, s53, s50
    buffer_load_dwordx4 v[116:119], v3, s[12:15], s50 offen nt
    s_add_u32 s50, s50, 0x8000
    s_cmp_eq_u32 s50, s51
    s_cselect_b32 s50, s53, s50
    buffer_load_dwordx4 v[120:123], v3, s[12:15], s50 offen nt
    s_add_u32 s50, s50, 0x8000
    s_cmp_eq_u32 s50, s51
    s_cselect_b32 s50, s53, s50
    buffer_load_dwordx4 v[124:127], v3, s[12:15], s50 offen nt
    s_add_u32 s50, s50, 0x8000
    s_cmp_eq_u32 s50, s51
    s_cselect_b32 s50, s53, s50
    buffer_load_dwordx4 v[128:131], v3, s[12:15], s50 offen nt
    s_add_u32 s50, s50, 0x8000
    s_cmp_eq_u32 s50, s51
    s_cselect_b32 s50, s53, s50
    buffer_load_dwordx4 v[132:135], v3, s[12:15], s50 offen nt
    s_add_u32 s50, s50, 0x8000
    s_cmp_eq_u32 s50, s51
    s_cselect_b32 s50, s53, s50
    buffer_load_dwordx4 v[136:139], v3, s[12:15], s50 offen nt
    s_add_u32 s50, s50, 0x8000
    s_cmp_eq_u32 s50, s51
    s_cselect_b32 s50, s53, s50
    buffer_load_dwordx4 v[140:143], v3, s[12:15], s50 offen nt
    s_add_u32 s50, s50, 0x8000
    s_cmp_eq_u32 s50, s51
    s_cselect_b32 s50, s53, s50
    buffer_load_dwordx4 v[144:147], v3, s[12:15], s50 offen nt
    s_add_u32 s50, s50, 0x8000
    s_cmp_eq_u32 s50, s51
    s_cselect_b32 s50, s53, s50
    buffer_load_dwordx4 v[148:151], v3, s[12:15], s50 offen nt
    s_add_u32 s50, s50, 0x8000
    s_cmp_eq_u32 s50, s51
    s_cselect_b32 s50, s53, s50
    buffer_load_dwordx4 v[152:155], v3, s[12:15], s50 offen nt
    s_add_u32 s50, s50, 0x8000
    s_cmp_eq_u32 s50, s51
    s_cselect_b32 s50, s53, s50
    buffer_load_dwordx4 v[156:159], v3, s[12:15], s50 offen nt
    s_add_u32 s50, s50, 0x8000
    s_cmp_eq_u32 s50, s51
    s_cselect_b32 s50, s53, s50
    buffer_load_dwordx4 v[160:163], v3, s[12:15], s50 offen nt
    s_add_u32 s50, s50, 0x8000
    s_cmp_eq_u32 s50, s51
    s_cselect_b32 s50, s53, s50
    buffer_load_dwordx4 v[164:167], v3, s[12:15], s50 offen nt
    s_add_u32 s50, s50, 0x8000
    s_cmp_eq_u32 s50, s51
    s_cselect_b32 s50, s53, s50
    buffer_load_dwordx4 v[168:171], v3, s[12:15], s50 offen nt
    s_add_u32 s50, s50, 0x8000
    s_cmp_eq_u32 s50, s51
    s_cselect_b32 s50, s53, s50
    buffer_load_dwordx4 v[172:175], v3, s[12:15], s50 offen nt
    s_add_u32 s50, s50, 0x8000
    s_cmp_eq_u32 s50, s51
    s_cselect_b32 s50, s53, s50
    buffer_load_dwordx4 v[176:179], v3, s[12:15], s50 offen nt
    s_add_u32 s50, s50, 0x8000
    s_cmp_eq_u32 s50, s51
    s_cselect_b32 s50, s53, s50
    buffer_load_dwordx4 v[180:183], v3, s[12:15], s50 offen nt
    s_add_u32 s50, s50, 0x8000
    s_cmp_eq_u32 s50, s51
    s_cselect_b32 s50, s53, s50
    buffer_load_dwordx4 v[184:187], v3, s[12:15], s50 offen nt
    s_add_u32 s50, s50, 0x8000
    s_cmp_eq_u32 s50, s51
    s_cselect_b32 s50, s53, s50
    buffer_load_dwordx4 v[188:191], v3, s[12:15], s50 offen nt
    s_add_u32 s50, s50, 0x8000
    s_cmp_eq_u32 s50, s51
    s_cselect_b32 s50, s53, s50
    buffer_load_dwordx4 v[192:195], v3, s[12:15], s50 offen nt
    s_add_u32 s50, s50, 0x8000
    s_cmp_eq_u32 s50, s51
    s_cselect_b32 s50, s53, s50
    buffer_load_dwordx4 v[196:199], v3, s[12:15], s50 offen nt
    s_add_u32 s50, s50, 0x8000
    s_cmp_eq_u32 s50, s51
    s_cselect_b32 s50, s53, s50
    buffer_load_dwordx4 v[200:203], v3, s[12:15], s50 offen nt
    s_add_u32 s50, s50, 0x8000
    s_cmp_eq_u32 s50, s51
    s_cselect_b32 s50, s53, s50
    buffer_load_dwordx4 v[204:207], v3, s[12:15], s50 offen nt
    s_add_u32 s50, s50, 0x8000
    s_cmp_eq_u32 s50, s51
    s_cselect_b32 s50, s53, s50
    buffer_load_dwordx4 v[208:211], v3, s[12:15], s50 offen nt
    s_add_u32 s50, s50, 0x8000
    s_cmp_eq_u32 s50, s51
    s_cselect_b32 s50, s53, s50
    buffer_load_dwordx4 v[212:215], v3, s[12:15], s50 offen nt
    s_add_u32 s50, s50, 0x8000
    s_cmp_eq_u32 s50, s51
    s_cselect_b32 s50, s53, s50
    buffer_load_dwordx4 v[216:219], v3, s[12:15], s50 offen nt
    s_add_u32 s50, s50, 0x8000
    s_cmp_eq_u32 s50, s51
    s_cselect_b32 s50, s53, s50
    buffer_load_dwordx4 v[220:223], v3, s[12:15], s50 offen nt
    s_barrier
    s_mov_b32 s60, 0xaaaaaaaa
    s_mov_b32 s61, 0xaaaaaaaa
    v_mov_b32 v8, 0xffff
    v_mov_b32 v9, 0xffff0000
    v_cndmask_b32_e64 v8, v8, v9, s[60:61]
    s_mov_b32 s60, 0x3030303
    s_mov_b32 s61, 0x3030303
    v_cndmask_b32_e64 v4, 0, v8, s[60:61]
    s_mov_b32 s60, 0xc0c0c0c
    s_mov_b32 s61, 0xc0c0c0c
    v_cndmask_b32_e64 v5, 0, v8, s[60:61]
    s_mov_b32 s60, 0x30303030
    s_mov_b32 s61, 0x30303030
    v_cndmask_b32_e64 v6, 0, v8, s[60:61]
    s_mov_b32 s60, 0xc0c0c0c0
    s_mov_b32 s61, 0xc0c0c0c0
    v_cndmask_b32_e64 v7, 0, v8, s[60:61]
    v_mov_b32 v52, -1
    v_mov_b32 v53, -1
    v_mov_b32 v54, -1
    v_mov_b32 v55, -1
    v_mov_b32 v9, 2048
    ds_write_b128 v9, v[52:55]
    s_mov_b32 s16, s72
    s_mov_b32 s17, s73
    s_mov_b32 s18, 0x500000
    s_mov_b32 s19, 0x20000
    s_mov_b32 s20, s86
    s_mov_b32 s21, s87
    s_mov_b32 s22, 0x40000000
    s_mov_b32 s23, 0x20000
    s_mov_b32 s24, s84
    s_mov_b32 s25, s85
    s_mov_b32 s26, 0x100
    s_mov_b32 s27, 0x20000
    s_mov_b32 s28, s82
    s_mov_b32 s29, s83
    s_mov_b32 s30, 0x1400
    s_mov_b32 s31, 0x20000
    s_waitcnt vmcnt(40)
    v_lshlrev_b32 v10, 16, v10
    v_lshlrev_b32 v11, 16, v11
    v_lshlrev_b32 v12, 16, v12
    v_lshlrev_b32 v13, 16, v13
    v_lshlrev_b32 v14, 16, v14
    v_lshlrev_b32 v15, 16, v15
    v_lshlrev_b32 v16, 16, v16
    v_lshlrev_b32 v17, 16, v17
    v_lshlrev_b32 v18, 16, v18
    v_lshlrev_b32 v19, 16, v19
    v_add_f32 v52, v10, v11
    v_add_f32 v53, v12, v13
    v_add_f32 v52, v52, v14
    v_add_f32 v53, v53, v15
    v_add_f32 v52, v52, v16
    v_add_f32 v53, v53, v17
    v_add_f32 v52, v52, v18
    v_add_f32 v53, v53, v19
    v_add_f32 v52, v52, v53
    s_nop 1
    v_add_f32_dpp v52, v52, v52 row_ror:8 row_mask:0xf bank_mask:0xf
    s_nop 1
    v_add_f32_dpp v52, v52, v52 row_ror:4 row_mask:0xf bank_mask:0xf
    s_nop 1
    v_add_f32_dpp v52, v52, v52 row_ror:2 row_mask:0xf bank_mask:0xf
    s_nop 1
    v_add_f32_dpp v52, v52, v52 row_ror:1 row_mask:0xf bank_mask:0xf
    s_nop 1
    v_add_f32_dpp v52, v52, v52 row_bcast:15 row_mask:0xa bank_mask:0xf
    s_nop 1
    v_add_f32_dpp v52, v52, v52 row_bcast:31 row_mask:0xc bank_mask:0xf
    s_nop 1
    v_readlane_b32 s52, v52, 63
    s_nop 1
    v_mov_b32 v52, 0x3acccccd
    v_mul_f32 v52, s52, v52
    v_sub_f32 v53, v10, v52
    v_mul_f32 v54, v53, v53
    v_sub_f32 v53, v11, v52
    v_fmac_f32 v54, v53, v53
    v_sub_f32 v53, v12, v52
    v_fmac_f32 v54, v53, v53
    v_sub_f32 v53, v13, v52
    v_fmac_f32 v54, v53, v53
    v_sub_f32 v53, v14, v52
    v_fmac_f32 v54, v53, v53
    v_sub_f32 v53, v15, v52
    v_fmac_f32 v54, v53, v53
    v_sub_f32 v53, v16, v52
    v_fmac_f32 v54, v53, v53
    v_sub_f32 v53, v17, v52
    v_fmac_f32 v54, v53, v53
    v_sub_f32 v53, v18, v52
    v_fmac_f32 v54, v53, v53
    v_sub_f32 v53, v19, v52
    v_fmac_f32 v54, v53, v53
    s_nop 1
    v_add_f32_dpp v54, v54, v54 row_ror:8 row_mask:0xf bank_mask:0xf
    s_nop 1
    v_add_f32_dpp v54, v54, v54 row_ror:4 row_mask:0xf bank_mask:0xf
    s_nop 1
    v_add_f32_dpp v54, v54, v54 row_ror:2 row_mask:0xf bank_mask:0xf
    s_nop 1
    v_add_f32_dpp v54, v54, v54 row_ror:1 row_mask:0xf bank_mask:0xf
    s_nop 1
    v_add_f32_dpp v54, v54, v54 row_bcast:15 row_mask:0xa bank_mask:0xf
    s_nop 1
    v_add_f32_dpp v54, v54, v54 row_bcast:31 row_mask:0xc bank_mask:0xf
    s_nop 1
    v_readlane_b32 s53, v54, 63
    s_nop 1
    v_mov_b32 v54, 0x3acccccd
    v_mul_f32 v54, s53, v54
    v_cvt_pk_bf16_f32 v52, v52, v52
    v_and_b32 v52, 0xffff0000, v52
    v_cvt_pk_bf16_f32 v54, v54, v54
    v_and_b32 v54, 0xffff0000, v54
    v_add_f32 v54, 0x3727c5ac, v54
    v_cvt_pk_bf16_f32 v54, v54, v54
    v_and_b32 v54, 0xffff0000, v54
    v_sqrt_f32 v54, v54
    s_nop 0
    v_cvt_pk_bf16_f32 v54, v54, v54
    v_and_b32 v54, 0xffff0000, v54
    v_rcp_f32 v54, v54
    s_nop 0
    v_sub_f32 v10, v10, v52
    v_cvt_pk_bf16_f32 v10, v10, v10
    v_and_b32 v10, 0xffff0000, v10
    v_mul_f32 v10, v10, v54
    v_cvt_pk_bf16_f32 v10, v10, v10
    v_sub_f32 v11, v11, v52
    v_cvt_pk_bf16_f32 v11, v11, v11
    v_and_b32 v11, 0xffff0000, v11
    v_mul_f32 v11, v11, v54
    v_cvt_pk_bf16_f32 v11, v11, v11
    v_sub_f32 v12, v12, v52
    v_cvt_pk_bf16_f32 v12, v12, v12
    v_and_b32 v12, 0xffff0000, v12
    v_mul_f32 v12, v12, v54
    v_cvt_pk_bf16_f32 v12, v12, v12
    s_nop 1
    v_and_b32_dpp v20, v10, v4 row_newbcast:0 row_mask:0xf bank_mask:0xf
    v_and_b32_dpp v21, v10, v5 row_newbcast:0 row_mask:0xf bank_mask:0xf
    v_and_b32_dpp v22, v10, v6 row_newbcast:0 row_mask:0xf bank_mask:0xf
    v_and_b32_dpp v23, v10, v7 row_newbcast:0 row_mask:0xf bank_mask:0xf
    v_and_b32_dpp v24, v10, v4 row_newbcast:1 row_mask:0xf bank_mask:0xf
    v_and_b32_dpp v25, v10, v5 row_newbcast:1 row_mask:0xf bank_mask:0xf
    v_and_b32_dpp v26, v10, v6 row_newbcast:1 row_mask:0xf bank_mask:0xf
    v_and_b32_dpp v27, v10, v7 row_newbcast:1 row_mask:0xf bank_mask:0xf
    s_waitcnt vmcnt(39)
    v_mfma_f32_16x16x32_bf16 v[28:31], v[20:23], v[64:67], 0
    v_and_b32_dpp v20, v10, v4 row_newbcast:2 row_mask:0xf bank_mask:0xf
    v_and_b32_dpp v21, v10, v5 row_newbcast:2 row_mask:0xf bank_mask:0xf
    v_and_b32_dpp v22, v10, v6 row_newbcast:2 row_mask:0xf bank_mask:0xf
    v_and_b32_dpp v23, v10, v7 row_newbcast:2 row_mask:0xf bank_mask:0xf
    s_waitcnt vmcnt(38)
    v_mfma_f32_16x16x32_bf16 v[28:31], v[24:27], v[68:71], v[28:31]
    v_and_b32_dpp v24, v10, v4 row_newbcast:3 row_mask:0xf bank_mask:0xf
    v_and_b32_dpp v25, v10, v5 row_newbcast:3 row_mask:0xf bank_mask:0xf
    v_and_b32_dpp v26, v10, v6 row_newbcast:3 row_mask:0xf bank_mask:0xf
    v_and_b32_dpp v27, v10, v7 row_newbcast:3 row_mask:0xf bank_mask:0xf
    s_waitcnt vmcnt(37)
    v_mfma_f32_16x16x32_bf16 v[28:31], v[20:23], v[72:75], v[28:31]
    v_and_b32_dpp v20, v10, v4 row_newbcast:4 row_mask:0xf bank_mask:0xf
    v_and_b32_dpp v21, v10, v5 row_newbcast:4 row_mask:0xf bank_mask:0xf
    v_and_b32_dpp v22, v10, v6 row_newbcast:4 row_mask:0xf bank_mask:0xf
    v_and_b32_dpp v23, v10, v7 row_newbcast:4 row_mask:0xf bank_mask:0xf
    s_waitcnt vmcnt(36)
    v_mfma_f32_16x16x32_bf16 v[28:31], v[24:27], v[76:79], v[28:31]
    v_and_b32_dpp v24, v10, v4 row_newbcast:5 row_mask:0xf bank_mask:0xf
    v_and_b32_dpp v25, v10, v5 row_newbcast:5 row_mask:0xf bank_mask:0xf
    v_and_b32_dpp v26, v10, v6 row_newbcast:5 row_mask:0xf bank_mask:0xf
    v_and_b32_dpp v27, v10, v7 row_newbcast:5 row_mask:0xf bank_mask:0xf
    s_waitcnt vmcnt(35)
    v_mfma_f32_16x16x32_bf16 v[28:31], v[20:23], v[80:83], v[28:31]
    v_and_b32_dpp v20, v10, v4 row_newbcast:6 row_mask:0xf bank_mask:0xf
    v_and_b32_dpp v21, v10, v5 row_newbcast:6 row_mask:0xf bank_mask:0xf
    v_and_b32_dpp v22, v10, v6 row_newbcast:6 row_mask:0xf bank_mask:0xf
    v_and_b32_dpp v23, v10, v7 row_newbcast:6 row_mask:0xf bank_mask:0xf
    s_waitcnt vmcnt(34)
    v_mfma_f32_16x16x32_bf16 v[28:31], v[24:27], v[84:87], v[28:31]
    v_and_b32_dpp v24, v10, v4 row_newbcast:7 row_mask:0xf bank_mask:0xf
    v_and_b32_dpp v25, v10, v5 row_newbcast:7 row_mask:0xf bank_mask:0xf
    v_and_b32_dpp v26, v10, v6 row_newbcast:7 row_mask:0xf bank_mask:0xf
    v_and_b32_dpp v27, v10, v7 row_newbcast:7 row_mask:0xf bank_mask:0xf
    s_waitcnt vmcnt(33)
    v_mfma_f32_16x16x32_bf16 v[28:31], v[20:23], v[88:91], v[28:31]
    v_and_b32_dpp v20, v10, v4 row_newbcast:8 row_mask:0xf bank_mask:0xf
    v_and_b32_dpp v21, v10, v5 row_newbcast:8 row_mask:0xf bank_mask:0xf
    v_and_b32_dpp v22, v10, v6 row_newbcast:8 row_mask:0xf bank_mask:0xf
    v_and_b32_dpp v23, v10, v7 row_newbcast:8 row_mask:0xf bank_mask:0xf
    s_waitcnt vmcnt(32)
    v_mfma_f32_16x16x32_bf16 v[28:31], v[24:27], v[92:95], v[28:31]
    v_and_b32_dpp v24, v10, v4 row_newbcast:9 row_mask:0xf bank_mask:0xf
    v_and_b32_dpp v25, v10, v5 row_newbcast:9 row_mask:0xf bank_mask:0xf
    v_and_b32_dpp v26, v10, v6 row_newbcast:9 row_mask:0xf bank_mask:0xf
    v_and_b32_dpp v27, v10, v7 row_newbcast:9 row_mask:0xf bank_mask:0xf
    s_waitcnt vmcnt(31)
    v_mfma_f32_16x16x32_bf16 v[28:31], v[20:23], v[96:99], v[28:31]
    v_and_b32_dpp v20, v10, v4 row_newbcast:10 row_mask:0xf bank_mask:0xf
    v_and_b32_dpp v21, v10, v5 row_newbcast:10 row_mask:0xf bank_mask:0xf
    v_and_b32_dpp v22, v10, v6 row_newbcast:10 row_mask:0xf bank_mask:0xf
    v_and_b32_dpp v23, v10, v7 row_newbcast:10 row_mask:0xf bank_mask:0xf
    s_waitcnt vmcnt(30)
    v_mfma_f32_16x16x32_bf16 v[28:31], v[24:27], v[100:103], v[28:31]
    v_and_b32_dpp v24, v10, v4 row_newbcast:11 row_mask:0xf bank_mask:0xf
    v_and_b32_dpp v25, v10, v5 row_newbcast:11 row_mask:0xf bank_mask:0xf
    v_and_b32_dpp v26, v10, v6 row_newbcast:11 row_mask:0xf bank_mask:0xf
    v_and_b32_dpp v27, v10, v7 row_newbcast:11 row_mask:0xf bank_mask:0xf
    s_waitcnt vmcnt(29)
    v_mfma_f32_16x16x32_bf16 v[28:31], v[20:23], v[104:107], v[28:31]
    v_and_b32_dpp v20, v10, v4 row_newbcast:12 row_mask:0xf bank_mask:0xf
    v_and_b32_dpp v21, v10, v5 row_newbcast:12 row_mask:0xf bank_mask:0xf
    v_and_b32_dpp v22, v10, v6 row_newbcast:12 row_mask:0xf bank_mask:0xf
    v_and_b32_dpp v23, v10, v7 row_newbcast:12 row_mask:0xf bank_mask:0xf
    s_waitcnt vmcnt(28)
    v_mfma_f32_16x16x32_bf16 v[28:31], v[24:27], v[108:111], v[28:31]
    v_and_b32_dpp v24, v10, v4 row_newbcast:13 row_mask:0xf bank_mask:0xf
    v_and_b32_dpp v25, v10, v5 row_newbcast:13 row_mask:0xf bank_mask:0xf
    v_and_b32_dpp v26, v10, v6 row_newbcast:13 row_mask:0xf bank_mask:0xf
    v_and_b32_dpp v27, v10, v7 row_newbcast:13 row_mask:0xf bank_mask:0xf
    s_waitcnt vmcnt(27)
    v_mfma_f32_16x16x32_bf16 v[28:31], v[20:23], v[112:115], v[28:31]
    v_and_b32_dpp v20, v10, v4 row_newbcast:14 row_mask:0xf bank_mask:0xf
    v_and_b32_dpp v21, v10, v5 row_newbcast:14 row_mask:0xf bank_mask:0xf
    v_and_b32_dpp v22, v10, v6 row_newbcast:14 row_mask:0xf bank_mask:0xf
    v_and_b32_dpp v23, v10, v7 row_newbcast:14 row_mask:0xf bank_mask:0xf
    s_waitcnt vmcnt(26)
    v_mfma_f32_16x16x32_bf16 v[28:31], v[24:27], v[116:119], v[28:31]
    v_and_b32_dpp v24, v10, v4 row_newbcast:15 row_mask:0xf bank_mask:0xf
    v_and_b32_dpp v25, v10, v5 row_newbcast:15 row_mask:0xf bank_mask:0xf
    v_and_b32_dpp v26, v10, v6 row_newbcast:15 row_mask:0xf bank_mask:0xf
    v_and_b32_dpp v27, v10, v7 row_newbcast:15 row_mask:0xf bank_mask:0xf
    s_waitcnt vmcnt(25)
    v_mfma_f32_16x16x32_bf16 v[28:31], v[20:23], v[120:123], v[28:31]
    v_and_b32_dpp v20, v11, v4 row_newbcast:0 row_mask:0xf bank_mask:0xf
    v_and_b32_dpp v21, v11, v5 row_newbcast:0 row_mask:0xf bank_mask:0xf
    v_and_b32_dpp v22, v11, v6 row_newbcast:0 row_mask:0xf bank_mask:0xf
    v_and_b32_dpp v23, v11, v7 row_newbcast:0 row_mask:0xf bank_mask:0xf
    s_waitcnt vmcnt(24)
    v_mfma_f32_16x16x32_bf16 v[28:31], v[24:27], v[124:127], v[28:31]
    v_and_b32_dpp v24, v11, v4 row_newbcast:1 row_mask:0xf bank_mask:0xf
    v_and_b32_dpp v25, v11, v5 row_newbcast:1 row_mask:0xf bank_mask:0xf
    v_and_b32_dpp v26, v11, v6 row_newbcast:1 row_mask:0xf bank_mask:0xf
    v_and_b32_dpp v27, v11, v7 row_newbcast:1 row_mask:0xf bank_mask:0xf
    s_waitcnt vmcnt(23)
    v_mfma_f32_16x16x32_bf16 v[28:31], v[20:23], v[128:131], v[28:31]
    v_and_b32_dpp v20, v11, v4 row_newbcast:2 row_mask:0xf bank_mask:0xf
    v_and_b32_dpp v21, v11, v5 row_newbcast:2 row_mask:0xf bank_mask:0xf
    v_and_b32_dpp v22, v11, v6 row_newbcast:2 row_mask:0xf bank_mask:0xf
    v_and_b32_dpp v23, v11, v7 row_newbcast:2 row_mask:0xf bank_mask:0xf
    s_waitcnt vmcnt(22)
    v_mfma_f32_16x16x32_bf16 v[28:31], v[24:27], v[132:135], v[28:31]
    v_and_b32_dpp v24, v11, v4 row_newbcast:3 row_mask:0xf bank_mask:0xf
    v_and_b32_dpp v25, v11, v5 row_newbcast:3 row_mask:0xf bank_mask:0xf
    v_and_b32_dpp v26, v11, v6 row_newbcast:3 row_mask:0xf bank_mask:0xf
    v_and_b32_dpp v27, v11, v7 row_newbcast:3 row_mask:0xf bank_mask:0xf
    s_waitcnt vmcnt(21)
    v_mfma_f32_16x16x32_bf16 v[28:31], v[20:23], v[136:139], v[28:31]
    v_and_b32_dpp v20, v11, v4 row_newbcast:4 row_mask:0xf bank_mask:0xf
    v_and_b32_dpp v21, v11, v5 row_newbcast:4 row_mask:0xf bank_mask:0xf
    v_and_b32_dpp v22, v11, v6 row_newbcast:4 row_mask:0xf bank_mask:0xf
    v_and_b32_dpp v23, v11, v7 row_newbcast:4 row_mask:0xf bank_mask:0xf
    s_waitcnt vmcnt(20)
    v_mfma_f32_16x16x32_bf16 v[28:31], v[24:27], v[140:143], v[28:31]
    v_and_b32_dpp v24, v11, v4 row_newbcast:5 row_mask:0xf bank_mask:0xf
    v_and_b32_dpp v25, v11, v5 row_newbcast:5 row_mask:0xf bank_mask:0xf
    v_and_b32_dpp v26, v11, v6 row_newbcast:5 row_mask:0xf bank_mask:0xf
    v_and_b32_dpp v27, v11, v7 row_newbcast:5 row_mask:0xf bank_mask:0xf
    s_waitcnt vmcnt(19)
    v_mfma_f32_16x16x32_bf16 v[28:31], v[20:23], v[144:147], v[28:31]
    v_and_b32_dpp v20, v11, v4 row_newbcast:6 row_mask:0xf bank_mask:0xf
    v_and_b32_dpp v21, v11, v5 row_newbcast:6 row_mask:0xf bank_mask:0xf
    v_and_b32_dpp v22, v11, v6 row_newbcast:6 row_mask:0xf bank_mask:0xf
    v_and_b32_dpp v23, v11, v7 row_newbcast:6 row_mask:0xf bank_mask:0xf
    s_waitcnt vmcnt(18)
    v_mfma_f32_16x16x32_bf16 v[28:31], v[24:27], v[148:151], v[28:31]
    v_and_b32_dpp v24, v11, v4 row_newbcast:7 row_mask:0xf bank_mask:0xf
    v_and_b32_dpp v25, v11, v5 row_newbcast:7 row_mask:0xf bank_mask:0xf
    v_and_b32_dpp v26, v11, v6 row_newbcast:7 row_mask:0xf bank_mask:0xf
    v_and_b32_dpp v27, v11, v7 row_newbcast:7 row_mask:0xf bank_mask:0xf
    s_waitcnt vmcnt(17)
    v_mfma_f32_16x16x32_bf16 v[28:31], v[20:23], v[152:155], v[28:31]
    v_and_b32_dpp v20, v11, v4 row_newbcast:8 row_mask:0xf bank_mask:0xf
    v_and_b32_dpp v21, v11, v5 row_newbcast:8 row_mask:0xf bank_mask:0xf
    v_and_b32_dpp v22, v11, v6 row_newbcast:8 row_mask:0xf bank_mask:0xf
    v_and_b32_dpp v23, v11, v7 row_newbcast:8 row_mask:0xf bank_mask:0xf
    s_waitcnt vmcnt(16)
    v_mfma_f32_16x16x32_bf16 v[28:31], v[24:27], v[156:159], v[28:31]
    v_and_b32_dpp v24, v11, v4 row_newbcast:9 row_mask:0xf bank_mask:0xf
    v_and_b32_dpp v25, v11, v5 row_newbcast:9 row_mask:0xf bank_mask:0xf
    v_and_b32_dpp v26, v11, v6 row_newbcast:9 row_mask:0xf bank_mask:0xf
    v_and_b32_dpp v27, v11, v7 row_newbcast:9 row_mask:0xf bank_mask:0xf
    s_waitcnt vmcnt(15)
    v_mfma_f32_16x16x32_bf16 v[28:31], v[20:23], v[160:163], v[28:31]
    v_and_b32_dpp v20, v11, v4 row_newbcast:10 row_mask:0xf bank_mask:0xf
    v_and_b32_dpp v21, v11, v5 row_newbcast:10 row_mask:0xf bank_mask:0xf
    v_and_b32_dpp v22, v11, v6 row_newbcast:10 row_mask:0xf bank_mask:0xf
    v_and_b32_dpp v23, v11, v7 row_newbcast:10 row_mask:0xf bank_mask:0xf
    s_waitcnt vmcnt(14)
    v_mfma_f32_16x16x32_bf16 v[28:31], v[24:27], v[164:167], v[28:31]
    v_and_b32_dpp v24, v11, v4 row_newbcast:11 row_mask:0xf bank_mask:0xf
    v_and_b32_dpp v25, v11, v5 row_newbcast:11 row_mask:0xf bank_mask:0xf
    v_and_b32_dpp v26, v11, v6 row_newbcast:11 row_mask:0xf bank_mask:0xf
    v_and_b32_dpp v27, v11, v7 row_newbcast:11 row_mask:0xf bank_mask:0xf
    s_waitcnt vmcnt(13)
    v_mfma_f32_16x16x32_bf16 v[28:31], v[20:23], v[168:171], v[28:31]
    v_and_b32_dpp v20, v11, v4 row_newbcast:12 row_mask:0xf bank_mask:0xf
    v_and_b32_dpp v21, v11, v5 row_newbcast:12 row_mask:0xf bank_mask:0xf
    v_and_b32_dpp v22, v11, v6 row_newbcast:12 row_mask:0xf bank_mask:0xf
    v_and_b32_dpp v23, v11, v7 row_newbcast:12 row_mask:0xf bank_mask:0xf
    s_waitcnt vmcnt(12)
    v_mfma_f32_16x16x32_bf16 v[28:31], v[24:27], v[172:175], v[28:31]
    v_and_b32_dpp v24, v11, v4 row_newbcast:13 row_mask:0xf bank_mask:0xf
    v_and_b32_dpp v25, v11, v5 row_newbcast:13 row_mask:0xf bank_mask:0xf
    v_and_b32_dpp v26, v11, v6 row_newbcast:13 row_mask:0xf bank_mask:0xf
    v_and_b32_dpp v27, v11, v7 row_newbcast:13 row_mask:0xf bank_mask:0xf
    s_waitcnt vmcnt(11)
    v_mfma_f32_16x16x32_bf16 v[28:31], v[20:23], v[176:179], v[28:31]
    v_and_b32_dpp v20, v11, v4 row_newbcast:14 row_mask:0xf bank_mask:0xf
    v_and_b32_dpp v21, v11, v5 row_newbcast:14 row_mask:0xf bank_mask:0xf
    v_and_b32_dpp v22, v11, v6 row_newbcast:14 row_mask:0xf bank_mask:0xf
    v_and_b32_dpp v23, v11, v7 row_newbcast:14 row_mask:0xf bank_mask:0xf
    s_waitcnt vmcnt(10)
    v_mfma_f32_16x16x32_bf16 v[28:31], v[24:27], v[180:183], v[28:31]
    v_and_b32_dpp v24, v11, v4 row_newbcast:15 row_mask:0xf bank_mask:0xf
    v_and_b32_dpp v25, v11, v5 row_newbcast:15 row_mask:0xf bank_mask:0xf
    v_and_b32_dpp v26, v11, v6 row_newbcast:15 row_mask:0xf bank_mask:0xf
    v_and_b32_dpp v27, v11, v7 row_newbcast:15 row_mask:0xf bank_mask:0xf
    s_waitcnt vmcnt(9)
    v_mfma_f32_16x16x32_bf16 v[28:31], v[20:23], v[184:187], v[28:31]
    v_and_b32_dpp v20, v12, v4 row_newbcast:0 row_mask:0xf bank_mask:0xf
    v_and_b32_dpp v21, v12, v5 row_newbcast:0 row_mask:0xf bank_mask:0xf
    v_and_b32_dpp v22, v12, v6 row_newbcast:0 row_mask:0xf bank_mask:0xf
    v_and_b32_dpp v23, v12, v7 row_newbcast:0 row_mask:0xf bank_mask:0xf
    s_waitcnt vmcnt(8)
    v_mfma_f32_16x16x32_bf16 v[28:31], v[24:27], v[188:191], v[28:31]
    v_and_b32_dpp v24, v12, v4 row_newbcast:1 row_mask:0xf bank_mask:0xf
    v_and_b32_dpp v25, v12, v5 row_newbcast:1 row_mask:0xf bank_mask:0xf
    v_and_b32_dpp v26, v12, v6 row_newbcast:1 row_mask:0xf bank_mask:0xf
    v_and_b32_dpp v27, v12, v7 row_newbcast:1 row_mask:0xf bank_mask:0xf
    s_waitcnt vmcnt(7)
    v_mfma_f32_16x16x32_bf16 v[28:31], v[20:23], v[192:195], v[28:31]
    v_and_b32_dpp v20, v12, v4 row_newbcast:2 row_mask:0xf bank_mask:0xf
    v_and_b32_dpp v21, v12, v5 row_newbcast:2 row_mask:0xf bank_mask:0xf
    v_and_b32_dpp v22, v12, v6 row_newbcast:2 row_mask:0xf bank_mask:0xf
    v_and_b32_dpp v23, v12, v7 row_newbcast:2 row_mask:0xf bank_mask:0xf
    s_waitcnt vmcnt(6)
    v_mfma_f32_16x16x32_bf16 v[28:31], v[24:27], v[196:199], v[28:31]
    v_and_b32_dpp v24, v12, v4 row_newbcast:3 row_mask:0xf bank_mask:0xf
    v_and_b32_dpp v25, v12, v5 row_newbcast:3 row_mask:0xf bank_mask:0xf
    v_and_b32_dpp v26, v12, v6 row_newbcast:3 row_mask:0xf bank_mask:0xf
    v_and_b32_dpp v27, v12, v7 row_newbcast:3 row_mask:0xf bank_mask:0xf
    s_waitcnt vmcnt(5)
    v_mfma_f32_16x16x32_bf16 v[28:31], v[20:23], v[200:203], v[28:31]
    v_and_b32_dpp v20, v12, v4 row_newbcast:4 row_mask:0xf bank_mask:0xf
    v_and_b32_dpp v21, v12, v5 row_newbcast:4 row_mask:0xf bank_mask:0xf
    v_and_b32_dpp v22, v12, v6 row_newbcast:4 row_mask:0xf bank_mask:0xf
    v_and_b32_dpp v23, v12, v7 row_newbcast:4 row_mask:0xf bank_mask:0xf
    s_waitcnt vmcnt(4)
    v_mfma_f32_16x16x32_bf16 v[28:31], v[24:27], v[204:207], v[28:31]
    v_and_b32_dpp v24, v12, v4 row_newbcast:5 row_mask:0xf bank_mask:0xf
    v_and_b32_dpp v25, v12, v5 row_newbcast:5 row_mask:0xf bank_mask:0xf
    v_and_b32_dpp v26, v12, v6 row_newbcast:5 row_mask:0xf bank_mask:0xf
    v_and_b32_dpp v27, v12, v7 row_newbcast:5 row_mask:0xf bank_mask:0xf
    s_waitcnt vmcnt(3)
    v_mfma_f32_16x16x32_bf16 v[28:31], v[20:23], v[208:211], v[28:31]
    v_and_b32_dpp v20, v12, v4 row_newbcast:6 row_mask:0xf bank_mask:0xf
    v_and_b32_dpp v21, v12, v5 row_newbcast:6 row_mask:0xf bank_mask:0xf
    v_and_b32_dpp v22, v12, v6 row_newbcast:6 row_mask:0xf bank_mask:0xf
    v_and_b32_dpp v23, v12, v7 row_newbcast:6 row_mask:0xf bank_mask:0xf
    s_waitcnt vmcnt(2)
    v_mfma_f32_16x16x32_bf16 v[28:31], v[24:27], v[212:215], v[28:31]
    v_and_b32_dpp v24, v12, v4 row_newbcast:7 row_mask:0xf bank_mask:0xf
    v_and_b32_dpp v25, v12, v5 row_newbcast:7 row_mask:0xf bank_mask:0xf
    v_and_b32_dpp v26, v12, v6 row_newbcast:7 row_mask:0xf bank_mask:0xf
    v_and_b32_dpp v27, v12, v7 row_newbcast:7 row_mask:0xf bank_mask:0xf
    s_waitcnt vmcnt(1)
    v_mfma_f32_16x16x32_bf16 v[28:31], v[20:23], v[216:219], v[28:31]
    s_nop 1
    s_waitcnt vmcnt(0)
    v_mfma_f32_16x16x32_bf16 v[28:31], v[24:27], v[220:223], v[28:31]
    v_lshlrev_b32 v8, 5, v1
    v_and_b32 v9, 1, v2
    v_lshlrev_b32 v9, 4, v9
    v_add_u32 v8, v8, v9
    s_lshl_b32 s48, s5, 9
    v_add_u32 v9, s48, v8
    s_nop 3
    ds_write_b128 v9, v[28:31] offset:0
    s_waitcnt lgkmcnt(0)
    s_barrier
    s_cmp_eq_u32 s5, 1
    s_cbranch_scc0 L_wo_6
    s_cmp_lt_u32 s2, 216
    s_cbranch_scc0 L_w5_7
    s_mov_b32 s32, s76
    s_mov_b32 s33, s77
    s_mov_b32 s34, 0x21c000
    s_mov_b32 s35, 0x20000
    s_mov_b32 s36, s78
    s_mov_b32 s37, s79
    s_mov_b32 s38, 0x21c000
    s_mov_b32 s39, 0x20000
    v_mul_u32_u24 v11, 3456, v2
    v_lshlrev_b32 v12, 3, v1
    v_add_u32 v11, v11, v12
    s_lshr_b32 s54, s2, 3
    s_and_b32 s55, s2, 7
    s_lshl_b32 s48, s54, 7
    s_mul_i32 s49, s55, 276480
    s_add_u32 s48, s48, s49
    buffer_load_dwordx2 v[64:65], v11, s[32:35], s48 offen nt
    buffer_load_dwordx2 v[66:67], v11, s[36:39], s48 offen nt
    s_add_u32 s48, s48, 13824
    buffer_load_dwordx2 v[68:69], v11, s[32:35], s48 offen nt
    buffer_load_dwordx2 v[70:71], v11, s[36:39], s48 offen nt
    s_add_u32 s48, s48, 13824
    buffer_load_dwordx2 v[72:73], v11, s[32:35], s48 offen nt
    buffer_load_dwordx2 v[74:75], v11, s[36:39], s48 offen nt
    s_add_u32 s48, s48, 13824
    buffer_load_dwordx2 v[76:77], v11, s[32:35], s48 offen nt
    buffer_load_dwordx2 v[78:79], v11, s[36:39], s48 offen nt
    s_add_u32 s48, s48, 13824
    buffer_load_dwordx2 v[80:81], v11, s[32:35], s48 offen nt
    buffer_load_dwordx2 v[82:83], v11, s[36:39], s48 offen nt
    s_add_u32 s48, s48, 13824
    buffer_load_dwordx2 v[84:85], v11, s[32:35], s48 offen nt
    buffer_load_dwordx2 v[86:87], v11, s[36:39], s48 offen nt
    s_add_u32 s48, s48, 13824
    buffer_load_dwordx2 v[88:89], v11, s[32:35], s48 offen nt
    buffer_load_dwordx2 v[90:91], v11, s[36:39], s48 offen nt
    s_add_u32 s48, s48, 13824
    buffer_load_dwordx2 v[92:93], v11, s[32:35], s48 offen nt
    buffer_load_dwordx2 v[94:95], v11, s[36:39], s48 offen nt
    s_add_u32 s48, s48, 13824
    buffer_load_dwordx2 v[96:97], v11, s[32:35], s48 offen nt
    buffer_load_dwordx2 v[98:99], v11, s[36:39], s48 offen nt
    s_add_u32 s48, s48, 13824
    buffer_load_dwordx2 v[100:101], v11, s[32:35], s48 offen nt
    buffer_load_dwordx2 v[102:103], v11, s[36:39], s48 offen nt
    s_add_u32 s48, s48, 13824
    buffer_load_dwordx2 v[104:105], v11, s[32:35], s48 offen nt
    buffer_load_dwordx2 v[106:107], v11, s[36:39], s48 offen nt
    s_add_u32 s48, s48, 13824
    buffer_load_dwordx2 v[108:109], v11, s[32:35], s48 offen nt
    buffer_load_dwordx2 v[110:111], v11, s[36:39], s48 offen nt
    s_add_u32 s48, s48, 13824
    buffer_load_dwordx2 v[112:113], v11, s[32:35], s48 offen nt
    buffer_load_dwordx2 v[114:115], v11, s[36:39], s48 offen nt
    s_add_u32 s48, s48, 13824
    buffer_load_dwordx2 v[116:117], v11, s[32:35], s48 offen nt
    buffer_load_dwordx2 v[118:119], v11, s[36:39], s48 offen nt
    s_add_u32 s48, s48, 13824
    buffer_load_dwordx2 v[120:121], v11, s[32:35], s48 offen nt
    buffer_load_dwordx2 v[122:123], v11, s[36:39], s48 offen nt
    s_add_u32 s48, s48, 13824
    buffer_load_dwordx2 v[124:125], v11, s[32:35], s48 offen nt
    buffer_load_dwordx2 v[126:127], v11, s[36:39], s48 offen nt
    s_add_u32 s48, s48, 13824
    buffer_load_dwordx2 v[128:129], v11, s[32:35], s48 offen nt
    buffer_load_dwordx2 v[130:131], v11, s[36:39], s48 offen nt
    s_add_u32 s48, s48, 13824
    buffer_load_dwordx2 v[132:133], v11, s[32:35], s48 offen nt
    buffer_load_dwordx2 v[134:135], v11, s[36:39], s48 offen nt
    s_add_u32 s48, s48, 13824
    buffer_load_dwordx2 v[136:137], v11, s[32:35], s48 offen nt
    buffer_load_dwordx2 v[138:139], v11, s[36:39], s48 offen nt
    s_add_u32 s48, s48, 13824
    buffer_load_dwordx2 v[140:141], v11, s[32:35], s48 offen nt
    buffer_load_dwordx2 v[142:143], v11, s[36:39], s48 offen nt
    v_lshlrev_b32 v8, 2, v1
    v_add_u32 v8, v8, v2
    v_lshlrev_b32 v8, 1, v8
    s_mov_b32 s48, 0
    s_mov_b32 s49, 1280
    s_mov_b32 s50, 2560
    s_mov_b32 s51, 3840
    buffer_load_ushort v144, v8, s[8:11], s48 offen offset:0
    buffer_load_ushort v145, v8, s[8:11], s48 offen offset:128
    buffer_load_ushort v146, v8, s[8:11], s48 offen offset:256
    buffer_load_ushort v147, v8, s[8:11], s48 offen offset:384
    buffer_load_ushort v148, v8, s[8:11], s48 offen offset:512
    buffer_load_ushort v149, v8, s[8:11], s48 offen offset:640
    buffer_load_ushort v150, v8, s[8:11], s48 offen offset:768
    buffer_load_ushort v151, v8, s[8:11], s48 offen offset:896
    buffer_load_ushort v152, v8, s[8:11], s48 offen offset:1024
    buffer_load_ushort v153, v8, s[8:11], s48 offen offset:1152
    buffer_load_ushort v154, v8, s[8:11], s49 offen offset:0
    buffer_load_ushort v155, v8, s[8:11], s49 offen offset:128
    buffer_load_ushort v156, v8, s[8:11], s49 offen offset:256
    buffer_load_ushort v157, v8, s[8:11], s49 offen offset:384
    buffer_load_ushort v158, v8, s[8:11], s49 offen offset:512
    buffer_load_ushort v159, v8, s[8:11], s49 offen offset:640
    buffer_load_ushort v160, v8, s[8:11], s49 offen offset:768
    buffer_load_ushort v161, v8, s[8:11], s49 offen offset:896
    buffer_load_ushort v162, v8, s[8:11], s49 offen offset:1024
    buffer_load_ushort v163, v8, s[8:11], s49 offen offset:1152
    buffer_load_ushort v164, v8, s[8:11], s50 offen offset:0
    buffer_load_ushort v165, v8, s[8:11], s50 offen offset:128
    buffer_load_ushort v166, v8, s[8:11], s50 offen offset:256
    buffer_load_ushort v167, v8, s[8:11], s50 offen offset:384
    buffer_load_ushort v168, v8, s[8:11], s50 offen offset:512
    buffer_load_ushort v169, v8, s[8:11], s50 offen offset:640
    buffer_load_ushort v170, v8, s[8:11], s50 offen offset:768
    buffer_load_ushort v171, v8, s[8:11], s50 offen offset:896
    buffer_load_ushort v172, v8, s[8:11], s50 offen offset:1024
    buffer_load_ushort v173, v8, s[8:11], s50 offen offset:1152
    buffer_load_ushort v174, v8, s[8:11], s51 offen offset:0
    buffer_load_ushort v175, v8, s[8:11], s51 offen offset:128
    buffer_load_ushort v176, v8, s[8:11], s51 offen offset:256
    buffer_load_ushort v177, v8, s[8:11], s51 offen offset:384
    buffer_load_ushort v178, v8, s[8:11], s51 offen offset:512
    buffer_load_ushort v179, v8, s[8:11], s51 offen offset:640
    buffer_load_ushort v180, v8, s[8:11], s51 offen offset:768
    buffer_load_ushort v181, v8, s[8:11], s51 offen offset:896
    buffer_load_ushort v182, v8, s[8:11], s51 offen offset:1024
    buffer_load_ushort v183, v8, s[8:11], s51 offen offset:1152
    s_mov_b32 s60, 0xaaaaaaaa
    s_mov_b32 s61, 0xaaaaaaaa
    v_mov_b32 v52, 0xffff
    v_mov_b32 v53, 0xffff0000
    v_cndmask_b32_e64 v52, v52, v53, s[60:61]
    s_mov_b32 s60, 0x33333333
    s_mov_b32 s61, 0x33333333
    v_cndmask_b32_e64 v44, 0, v52, s[60:61]
    s_mov_b32 s60, 0xcccccccc
    s_mov_b32 s61, 0xcccccccc
    v_cndmask_b32_e64 v45, 0, v52, s[60:61]
    v_mul_u32_u24 v9, 640, v2
    v_lshlrev_b32 v52, 2, v1
    v_add_u32 v9, v9, v52
    s_waitcnt vmcnt(30)
    v_lshlrev_b32 v144, 16, v144
    v_lshlrev_b32 v145, 16, v145
    v_lshlrev_b32 v146, 16, v146
    v_lshlrev_b32 v147, 16, v147
    v_lshlrev_b32 v148, 16, v148
    v_lshlrev_b32 v149, 16, v149
    v_lshlrev_b32 v150, 16, v150
    v_lshlrev_b32 v151, 16, v151
    v_lshlrev_b32 v152, 16, v152
    v_lshlrev_b32 v153, 16, v153
    v_add_f32 v52, v144, v145
    v_add_f32 v53, v146, v147
    v_add_f32 v52, v52, v148
    v_add_f32 v53, v53, v149
    v_add_f32 v52, v52, v150
    v_add_f32 v53, v53, v151
    v_add_f32 v52, v52, v152
    v_add_f32 v53, v53, v153
    v_add_f32 v52, v52, v53
    s_nop 1
    v_add_f32_dpp v52, v52, v52 row_ror:8 row_mask:0xf bank_mask:0xf
    s_nop 1
    v_add_f32_dpp v52, v52, v52 row_ror:4 row_mask:0xf bank_mask:0xf
    s_nop 1
    v_add_f32_dpp v52, v52, v52 row_ror:2 row_mask:0xf bank_mask:0xf
    s_nop 1
    v_add_f32_dpp v52, v52, v52 row_ror:1 row_mask:0xf bank_mask:0xf
    s_nop 1
    v_add_f32_dpp v52, v52, v52 row_bcast:15 row_mask:0xa bank_mask:0xf
    s_nop 1
    v_add_f32_dpp v52, v52, v52 row_bcast:31 row_mask:0xc bank_mask:0xf
    s_nop 1
    v_readlane_b32 s52, v52, 63
    s_nop 1
    v_mov_b32 v52, 0x3acccccd
    v_mul_f32 v52, s52, v52
    v_sub_f32 v53, v144, v52
    v_mul_f32 v54, v53, v53
    v_sub_f32 v53, v145, v52
    v_fmac_f32 v54, v53, v53
    v_sub_f32 v53, v146, v52
    v_fmac_f32 v54, v53, v53
    v_sub_f32 v53, v147, v52
    v_fmac_f32 v54, v53, v53
    v_sub_f32 v53, v148, v52
    v_fmac_f32 v54, v53, v53
    v_sub_f32 v53, v149, v52
    v_fmac_f32 v54, v53, v53
    v_sub_f32 v53, v150, v52
    v_fmac_f32 v54, v53, v53
    v_sub_f32 v53, v151, v52
    v_fmac_f32 v54, v53, v53
    v_sub_f32 v53, v152, v52
    v_fmac_f32 v54, v53, v53
    v_sub_f32 v53, v153, v52
    v_fmac_f32 v54, v53, v53
    s_nop 1
    v_add_f32_dpp v54, v54, v54 row_ror:8 row_mask:0xf bank_mask:0xf
    s_nop 1
    v_add_f32_dpp v54, v54, v54 row_ror:4 row_mask:0xf bank_mask:0xf
    s_nop 1
    v_add_f32_dpp v54, v54, v54 row_ror:2 row_mask:0xf bank_mask:0xf
    s_nop 1
    v_add_f32_dpp v54, v54, v54 row_ror:1 row_mask:0xf bank_mask:0xf
    s_nop 1
    v_add_f32_dpp v54, v54, v54 row_bcast:15 row_mask:0xa bank_mask:0xf
    s_nop 1
    v_add_f32_dpp v54, v54, v54 row_bcast:31 row_mask:0xc bank_mask:0xf
    s_nop 1
    v_readlane_b32 s53, v54, 63
    s_nop 1
    v_mov_b32 v54, 0x3acccccd
    v_mul_f32 v54, s53, v54
    v_cvt_pk_bf16_f32 v52, v52, v52
    v_and_b32 v52, 0xffff0000, v52
    v_cvt_pk_bf16_f32 v54, v54, v54
    v_and_b32 v54, 0xffff0000, v54
    v_add_f32 v54, 0x3727c5ac, v54
    v_cvt_pk_bf16_f32 v54, v54, v54
    v_and_b32 v54, 0xffff0000, v54
    v_sqrt_f32 v54, v54
    s_nop 0
    v_cvt_pk_bf16_f32 v54, v54, v54
    v_and_b32 v54, 0xffff0000, v54
    v_rcp_f32 v54, v54
    s_nop 0
    v_sub_f32 v144, v144, v52
    v_cvt_pk_bf16_f32 v144, v144, v144
    v_and_b32 v144, 0xffff0000, v144
    v_mul_f32 v144, v144, v54
    v_cvt_pk_bf16_f32 v144, v144, v144
    v_sub_f32 v145, v145, v52
    v_cvt_pk_bf16_f32 v145, v145, v145
    v_and_b32 v145, 0xffff0000, v145
    v_mul_f32 v145, v145, v54
    v_cvt_pk_bf16_f32 v145, v145, v145
    v_sub_f32 v146, v146, v52
    v_cvt_pk_bf16_f32 v146, v146, v146
    v_and_b32 v146, 0xffff0000, v146
    v_mul_f32 v146, v146, v54
    v_cvt_pk_bf16_f32 v146, v146, v146
    v_sub_f32 v147, v147, v52
    v_cvt_pk_bf16_f32 v147, v147, v147
    v_and_b32 v147, 0xffff0000, v147
    v_mul_f32 v147, v147, v54
    v_cvt_pk_bf16_f32 v147, v147, v147
    v_sub_f32 v148, v148, v52
    v_cvt_pk_bf16_f32 v148, v148, v148
    v_and_b32 v148, 0xffff0000, v148
    v_mul_f32 v148, v148, v54
    v_cvt_pk_bf16_f32 v148, v148, v148
    v_sub_f32 v149, v149, v52
    v_cvt_pk_bf16_f32 v149, v149, v149
    v_and_b32 v149, 0xffff0000, v149
    v_mul_f32 v149, v149, v54
    v_cvt_pk_bf16_f32 v149, v149, v149
    v_sub_f32 v150, v150, v52
    v_cvt_pk_bf16_f32 v150, v150, v150
    v_and_b32 v150, 0xffff0000, v150
    v_mul_f32 v150, v150, v54
    v_cvt_pk_bf16_f32 v150, v150, v150
    v_sub_f32 v151, v151, v52
    v_cvt_pk_bf16_f32 v151, v151, v151
    v_and_b32 v151, 0xffff0000, v151
    v_mul_f32 v151, v151, v54
    v_cvt_pk_bf16_f32 v151, v151, v151
    v_sub_f32 v152, v152, v52
    v_cvt_pk_bf16_f32 v152, v152, v152
    v_and_b32 v152, 0xffff0000, v152
    v_mul_f32 v152, v152, v54
    v_cvt_pk_bf16_f32 v152, v152, v152
    v_sub_f32 v153, v153, v52
    v_cvt_pk_bf16_f32 v153, v153, v153
    v_and_b32 v153, 0xffff0000, v153
    v_mul_f32 v153, v153, v54
    v_cvt_pk_bf16_f32 v153, v153, v153
    ds_write_b32 v9, v144 offset:32768
    ds_write_b32 v9, v145 offset:32832
    ds_write_b32 v9, v146 offset:32896
    ds_write_b32 v9, v147 offset:32960
    ds_write_b32 v9, v148 offset:33024
    ds_write_b32 v9, v149 offset:33088
    ds_write_b32 v9, v150 offset:33152
    ds_write_b32 v9, v151 offset:33216
    ds_write_b32 v9, v152 offset:33280
    ds_write_b32 v9, v153 offset:33344
    s_waitcnt vmcnt(20)
    v_lshlrev_b32 v154, 16, v154
    v_lshlrev_b32 v155, 16, v155
    v_lshlrev_b32 v156, 16, v156
    v_lshlrev_b32 v157, 16, v157
    v_lshlrev_b32 v158, 16, v158
    v_lshlrev_b32 v159, 16, v159
    v_lshlrev_b32 v160, 16, v160
    v_lshlrev_b32 v161, 16, v161
    v_lshlrev_b32 v162, 16, v162
    v_lshlrev_b32 v163, 16, v163
    v_add_f32 v52, v154, v155
    v_add_f32 v53, v156, v157
    v_add_f32 v52, v52, v158
    v_add_f32 v53, v53, v159
    v_add_f32 v52, v52, v160
    v_add_f32 v53, v53, v161
    v_add_f32 v52, v52, v162
    v_add_f32 v53, v53, v163
    v_add_f32 v52, v52, v53
    s_nop 1
    v_add_f32_dpp v52, v52, v52 row_ror:8 row_mask:0xf bank_mask:0xf
    s_nop 1
    v_add_f32_dpp v52, v52, v52 row_ror:4 row_mask:0xf bank_mask:0xf
    s_nop 1
    v_add_f32_dpp v52, v52, v52 row_ror:2 row_mask:0xf bank_mask:0xf
    s_nop 1
    v_add_f32_dpp v52, v52, v52 row_ror:1 row_mask:0xf bank_mask:0xf
    s_nop 1
    v_add_f32_dpp v52, v52, v52 row_bcast:15 row_mask:0xa bank_mask:0xf
    s_nop 1
    v_add_f32_dpp v52, v52, v52 row_bcast:31 row_mask:0xc bank_mask:0xf
    s_nop 1
    v_readlane_b32 s52, v52, 63
    s_nop 1
    v_mov_b32 v52, 0x3acccccd
    v_mul_f32 v52, s52, v52
    v_sub_f32 v53, v154, v52
    v_mul_f32 v54, v53, v53
    v_sub_f32 v53, v155, v52
    v_fmac_f32 v54, v53, v53
    v_sub_f32 v53, v156, v52
    v_fmac_f32 v54, v53, v53
    v_sub_f32 v53, v157, v52
    v_fmac_f32 v54, v53, v53
    v_sub_f32 v53, v158, v52
    v_fmac_f32 v54, v53, v53
    v_sub_f32 v53, v159, v52
    v_fmac_f32 v54, v53, v53
    v_sub_f32 v53, v160, v52
    v_fmac_f32 v54, v53, v53
    v_sub_f32 v53, v161, v52
    v_fmac_f32 v54, v53, v53
    v_sub_f32 v53, v162, v52
    v_fmac_f32 v54, v53, v53
    v_sub_f32 v53, v163, v52
    v_fmac_f32 v54, v53, v53
    s_nop 1
    v_add_f32_dpp v54, v54, v54 row_ror:8 row_mask:0xf bank_mask:0xf
    s_nop 1
    v_add_f32_dpp v54, v54, v54 row_ror:4 row_mask:0xf bank_mask:0xf
    s_nop 1
    v_add_f32_dpp v54, v54, v54 row_ror:2 row_mask:0xf bank_mask:0xf
    s_nop 1
    v_add_f32_dpp v54, v54, v54 row_ror:1 row_mask:0xf bank_mask:0xf
    s_nop 1
    v_add_f32_dpp v54, v54, v54 row_bcast:15 row_mask:0xa bank_mask:0xf
    s_nop 1
    v_add_f32_dpp v54, v54, v54 row_bcast:31 row_mask:0xc bank_mask:0xf
    s_nop 1
    v_readlane_b32 s53, v54, 63
    s_nop 1
    v_mov_b32 v54, 0x3acccccd
    v_mul_f32 v54, s53, v54
    v_cvt_pk_bf16_f32 v52, v52, v52
    v_and_b32 v52, 0xffff0000, v52
    v_cvt_pk_bf16_f32 v54, v54, v54
    v_and_b32 v54, 0xffff0000, v54
    v_add_f32 v54, 0x3727c5ac, v54
    v_cvt_pk_bf16_f32 v54, v54, v54
    v_and_b32 v54, 0xffff0000, v54
    v_sqrt_f32 v54, v54
    s_nop 0
    v_cvt_pk_bf16_f32 v54, v54, v54
    v_and_b32 v54, 0xffff0000, v54
    v_rcp_f32 v54, v54
    s_nop 0
    v_sub_f32 v154, v154, v52
    v_cvt_pk_bf16_f32 v154, v154, v154
    v_and_b32 v154, 0xffff0000, v154
    v_mul_f32 v154, v154, v54
    v_cvt_pk_bf16_f32 v154, v154, v154
    v_sub_f32 v155, v155, v52
    v_cvt_pk_bf16_f32 v155, v155, v155
    v_and_b32 v155, 0xffff0000, v155
    v_mul_f32 v155, v155, v54
    v_cvt_pk_bf16_f32 v155, v155, v155
    v_sub_f32 v156, v156, v52
    v_cvt_pk_bf16_f32 v156, v156, v156
    v_and_b32 v156, 0xffff0000, v156
    v_mul_f32 v156, v156, v54
    v_cvt_pk_bf16_f32 v156, v156, v156
    v_sub_f32 v157, v157, v52
    v_cvt_pk_bf16_f32 v157, v157, v157
    v_and_b32 v157, 0xffff0000, v157
    v_mul_f32 v157, v157, v54
    v_cvt_pk_bf16_f32 v157, v157, v157
    v_sub_f32 v158, v158, v52
    v_cvt_pk_bf16_f32 v158, v158, v158
    v_and_b32 v158, 0xffff0000, v158
    v_mul_f32 v158, v158, v54
    v_cvt_pk_bf16_f32 v158, v158, v158
    v_sub_f32 v159, v159, v52
    v_cvt_pk_bf16_f32 v159, v159, v159
    v_and_b32 v159, 0xffff0000, v159
    v_mul_f32 v159, v159, v54
    v_cvt_pk_bf16_f32 v159, v159, v159
    v_sub_f32 v160, v160, v52
    v_cvt_pk_bf16_f32 v160, v160, v160
    v_and_b32 v160, 0xffff0000, v160
    v_mul_f32 v160, v160, v54
    v_cvt_pk_bf16_f32 v160, v160, v160
    v_sub_f32 v161, v161, v52
    v_cvt_pk_bf16_f32 v161, v161, v161
    v_and_b32 v161, 0xffff0000, v161
    v_mul_f32 v161, v161, v54
    v_cvt_pk_bf16_f32 v161, v161, v161
    v_sub_f32 v162, v162, v52
    v_cvt_pk_bf16_f32 v162, v162, v162
    v_and_b32 v162, 0xffff0000, v162
    v_mul_f32 v162, v162, v54
    v_cvt_pk_bf16_f32 v162, v162, v162
    v_sub_f32 v163, v163, v52
    v_cvt_pk_bf16_f32 v163, v163, v163
    v_and_b32 v163, 0xffff0000, v163
    v_mul_f32 v163, v163, v54
    v_cvt_pk_bf16_f32 v163, v163, v163
    ds_write_b32 v9, v154 offset:35328
    ds_write_b32 v9, v155 offset:35392
    ds_write_b32 v9, v156 offset:35456
    ds_write_b32 v9, v157 offset:35520
    ds_write_b32 v9, v158 offset:35584
    ds_write_b32 v9, v159 offset:35648
    ds_write_b32 v9, v160 offset:35712
    ds_write_b32 v9, v161 offset:35776
    ds_write_b32 v9, v162 offset:35840
    ds_write_b32 v9, v163 offset:35904
    s_waitcnt vmcnt(10)
    v_lshlrev_b32 v164, 16, v164
    v_lshlrev_b32 v165, 16, v165
    v_lshlrev_b32 v166, 16, v166
    v_lshlrev_b32 v167, 16, v167
    v_lshlrev_b32 v168, 16, v168
    v_lshlrev_b32 v169, 16, v169
    v_lshlrev_b32 v170, 16, v170
    v_lshlrev_b32 v171, 16, v171
    v_lshlrev_b32 v172, 16, v172
    v_lshlrev_b32 v173, 16, v173
    v_add_f32 v52, v164, v165
    v_add_f32 v53, v166, v167
    v_add_f32 v52, v52, v168
    v_add_f32 v53, v53, v169
    v_add_f32 v52, v52, v170
    v_add_f32 v53, v53, v171
    v_add_f32 v52, v52, v172
    v_add_f32 v53, v53, v173
    v_add_f32 v52, v52, v53
    s_nop 1
    v_add_f32_dpp v52, v52, v52 row_ror:8 row_mask:0xf bank_mask:0xf
    s_nop 1
    v_add_f32_dpp v52, v52, v52 row_ror:4 row_mask:0xf bank_mask:0xf
    s_nop 1
    v_add_f32_dpp v52, v52, v52 row_ror:2 row_mask:0xf bank_mask:0xf
    s_nop 1
    v_add_f32_dpp v52, v52, v52 row_ror:1 row_mask:0xf bank_mask:0xf
    s_nop 1
    v_add_f32_dpp v52, v52, v52 row_bcast:15 row_mask:0xa bank_mask:0xf
    s_nop 1
    v_add_f32_dpp v52, v52, v52 row_bcast:31 row_mask:0xc bank_mask:0xf
    s_nop 1
    v_readlane_b32 s52, v52, 63
    s_nop 1
    v_mov_b32 v52, 0x3acccccd
    v_mul_f32 v52, s52, v52
    v_sub_f32 v53, v164, v52
    v_mul_f32 v54, v53, v53
    v_sub_f32 v53, v165, v52
    v_fmac_f32 v54, v53, v53
    v_sub_f32 v53, v166, v52
    v_fmac_f32 v54, v53, v53
    v_sub_f32 v53, v167, v52
    v_fmac_f32 v54, v53, v53
    v_sub_f32 v53, v168, v52
    v_fmac_f32 v54, v53, v53
    v_sub_f32 v53, v169, v52
    v_fmac_f32 v54, v53, v53
    v_sub_f32 v53, v170, v52
    v_fmac_f32 v54, v53, v53
    v_sub_f32 v53, v171, v52
    v_fmac_f32 v54, v53, v53
    v_sub_f32 v53, v172, v52
    v_fmac_f32 v54, v53, v53
    v_sub_f32 v53, v173, v52
    v_fmac_f32 v54, v53, v53
    s_nop 1
    v_add_f32_dpp v54, v54, v54 row_ror:8 row_mask:0xf bank_mask:0xf
    s_nop 1
    v_add_f32_dpp v54, v54, v54 row_ror:4 row_mask:0xf bank_mask:0xf
    s_nop 1
    v_add_f32_dpp v54, v54, v54 row_ror:2 row_mask:0xf bank_mask:0xf
    s_nop 1
    v_add_f32_dpp v54, v54, v54 row_ror:1 row_mask:0xf bank_mask:0xf
    s_nop 1
    v_add_f32_dpp v54, v54, v54 row_bcast:15 row_mask:0xa bank_mask:0xf
    s_nop 1
    v_add_f32_dpp v54, v54, v54 row_bcast:31 row_mask:0xc bank_mask:0xf
    s_nop 1
    v_readlane_b32 s53, v54, 63
    s_nop 1
    v_mov_b32 v54, 0x3acccccd
    v_mul_f32 v54, s53, v54
    v_cvt_pk_bf16_f32 v52, v52, v52
    v_and_b32 v52, 0xffff0000, v52
    v_cvt_pk_bf16_f32 v54, v54, v54
    v_and_b32 v54, 0xffff0000, v54
    v_add_f32 v54, 0x3727c5ac, v54
    v_cvt_pk_bf16_f32 v54, v54, v54
    v_and_b32 v54, 0xffff0000, v54
    v_sqrt_f32 v54, v54
    s_nop 0
    v_cvt_pk_bf16_f32 v54, v54, v54
    v_and_b32 v54, 0xffff0000, v54
    v_rcp_f32 v54, v54
    s_nop 0
    v_sub_f32 v164, v164, v52
    v_cvt_pk_bf16_f32 v164, v164, v164
    v_and_b32 v164, 0xffff0000, v164
    v_mul_f32 v164, v164, v54
    v_cvt_pk_bf16_f32 v164, v164, v164
    v_sub_f32 v165, v165, v52
    v_cvt_pk_bf16_f32 v165, v165, v165
    v_and_b32 v165, 0xffff0000, v165
    v_mul_f32 v165, v165, v54
    v_cvt_pk_bf16_f32 v165, v165, v165
    v_sub_f32 v166, v166, v52
    v_cvt_pk_bf16_f32 v166, v166, v166
    v_and_b32 v166, 0xffff0000, v166
    v_mul_f32 v166, v166, v54
    v_cvt_pk_bf16_f32 v166, v166, v166
    v_sub_f32 v167, v167, v52
    v_cvt_pk_bf16_f32 v167, v167, v167
    v_and_b32 v167, 0xffff0000, v167
    v_mul_f32 v167, v167, v54
    v_cvt_pk_bf16_f32 v167, v167, v167
    v_sub_f32 v168, v168, v52
    v_cvt_pk_bf16_f32 v168, v168, v168
    v_and_b32 v168, 0xffff0000, v168
    v_mul_f32 v168, v168, v54
    v_cvt_pk_bf16_f32 v168, v168, v168
    v_sub_f32 v169, v169, v52
    v_cvt_pk_bf16_f32 v169, v169, v169
    v_and_b32 v169, 0xffff0000, v169
    v_mul_f32 v169, v169, v54
    v_cvt_pk_bf16_f32 v169, v169, v169
    v_sub_f32 v170, v170, v52
    v_cvt_pk_bf16_f32 v170, v170, v170
    v_and_b32 v170, 0xffff0000, v170
    v_mul_f32 v170, v170, v54
    v_cvt_pk_bf16_f32 v170, v170, v170
    v_sub_f32 v171, v171, v52
    v_cvt_pk_bf16_f32 v171, v171, v171
    v_and_b32 v171, 0xffff0000, v171
    v_mul_f32 v171, v171, v54
    v_cvt_pk_bf16_f32 v171, v171, v171
    v_sub_f32 v172, v172, v52
    v_cvt_pk_bf16_f32 v172, v172, v172
    v_and_b32 v172, 0xffff0000, v172
    v_mul_f32 v172, v172, v54
    v_cvt_pk_bf16_f32 v172, v172, v172
    v_sub_f32 v173, v173, v52
    v_cvt_pk_bf16_f32 v173, v173, v173
    v_and_b32 v173, 0xffff0000, v173
    v_mul_f32 v173, v173, v54
    v_cvt_pk_bf16_f32 v173, v173, v173
    ds_write_b32 v9, v164 offset:37888
    ds_write_b32 v9, v165 offset:37952
    ds_write_b32 v9, v166 offset:38016
    ds_write_b32 v9, v167 offset:38080
    ds_write_b32 v9, v168 offset:38144
    ds_write_b32 v9, v169 offset:38208
    ds_write_b32 v9, v170 offset:38272
    ds_write_b32 v9, v171 offset:38336
    ds_write_b32 v9, v172 offset:38400
    ds_write_b32 v9, v173 offset:38464
    s_waitcnt vmcnt(0)
    v_lshlrev_b32 v174, 16, v174
    v_lshlrev_b32 v175, 16, v175
    v_lshlrev_b32 v176, 16, v176
    v_lshlrev_b32 v177, 16, v177
    v_lshlrev_b32 v178, 16, v178
    v_lshlrev_b32 v179, 16, v179
    v_lshlrev_b32 v180, 16, v180
    v_lshlrev_b32 v181, 16, v181
    v_lshlrev_b32 v182, 16, v182
    v_lshlrev_b32 v183, 16, v183
    v_add_f32 v52, v174, v175
    v_add_f32 v53, v176, v177
    v_add_f32 v52, v52, v178
    v_add_f32 v53, v53, v179
    v_add_f32 v52, v52, v180
    v_add_f32 v53, v53, v181
    v_add_f32 v52, v52, v182
    v_add_f32 v53, v53, v183
    v_add_f32 v52, v52, v53
    s_nop 1
    v_add_f32_dpp v52, v52, v52 row_ror:8 row_mask:0xf bank_mask:0xf
    s_nop 1
    v_add_f32_dpp v52, v52, v52 row_ror:4 row_mask:0xf bank_mask:0xf
    s_nop 1
    v_add_f32_dpp v52, v52, v52 row_ror:2 row_mask:0xf bank_mask:0xf
    s_nop 1
    v_add_f32_dpp v52, v52, v52 row_ror:1 row_mask:0xf bank_mask:0xf
    s_nop 1
    v_add_f32_dpp v52, v52, v52 row_bcast:15 row_mask:0xa bank_mask:0xf
    s_nop 1
    v_add_f32_dpp v52, v52, v52 row_bcast:31 row_mask:0xc bank_mask:0xf
    s_nop 1
    v_readlane_b32 s52, v52, 63
    s_nop 1
    v_mov_b32 v52, 0x3acccccd
    v_mul_f32 v52, s52, v52
    v_sub_f32 v53, v174, v52
    v_mul_f32 v54, v53, v53
    v_sub_f32 v53, v175, v52
    v_fmac_f32 v54, v53, v53
    v_sub_f32 v53, v176, v52
    v_fmac_f32 v54, v53, v53
    v_sub_f32 v53, v177, v52
    v_fmac_f32 v54, v53, v53
    v_sub_f32 v53, v178, v52
    v_fmac_f32 v54, v53, v53
    v_sub_f32 v53, v179, v52
    v_fmac_f32 v54, v53, v53
    v_sub_f32 v53, v180, v52
    v_fmac_f32 v54, v53, v53
    v_sub_f32 v53, v181, v52
    v_fmac_f32 v54, v53, v53
    v_sub_f32 v53, v182, v52
    v_fmac_f32 v54, v53, v53
    v_sub_f32 v53, v183, v52
    v_fmac_f32 v54, v53, v53
    s_nop 1
    v_add_f32_dpp v54, v54, v54 row_ror:8 row_mask:0xf bank_mask:0xf
    s_nop 1
    v_add_f32_dpp v54, v54, v54 row_ror:4 row_mask:0xf bank_mask:0xf
    s_nop 1
    v_add_f32_dpp v54, v54, v54 row_ror:2 row_mask:0xf bank_mask:0xf
    s_nop 1
    v_add_f32_dpp v54, v54, v54 row_ror:1 row_mask:0xf bank_mask:0xf
    s_nop 1
    v_add_f32_dpp v54, v54, v54 row_bcast:15 row_mask:0xa bank_mask:0xf
    s_nop 1
    v_add_f32_dpp v54, v54, v54 row_bcast:31 row_mask:0xc bank_mask:0xf
    s_nop 1
    v_readlane_b32 s53, v54, 63
    s_nop 1
    v_mov_b32 v54, 0x3acccccd
    v_mul_f32 v54, s53, v54
    v_cvt_pk_bf16_f32 v52, v52, v52
    v_and_b32 v52, 0xffff0000, v52
    v_cvt_pk_bf16_f32 v54, v54, v54
    v_and_b32 v54, 0xffff0000, v54
    v_add_f32 v54, 0x3727c5ac, v54
    v_cvt_pk_bf16_f32 v54, v54, v54
    v_and_b32 v54, 0xffff0000, v54
    v_sqrt_f32 v54, v54
    s_nop 0
    v_cvt_pk_bf16_f32 v54, v54, v54
    v_and_b32 v54, 0xffff0000, v54
    v_rcp_f32 v54, v54
    s_nop 0
    v_sub_f32 v174, v174, v52
    v_cvt_pk_bf16_f32 v174, v174, v174
    v_and_b32 v174, 0xffff0000, v174
    v_mul_f32 v174, v174, v54
    v_cvt_pk_bf16_f32 v174, v174, v174
    v_sub_f32 v175, v175, v52
    v_cvt_pk_bf16_f32 v175, v175, v175
    v_and_b32 v175, 0xffff0000, v175
    v_mul_f32 v175, v175, v54
    v_cvt_pk_bf16_f32 v175, v175, v175
    v_sub_f32 v176, v176, v52
    v_cvt_pk_bf16_f32 v176, v176, v176
    v_and_b32 v176, 0xffff0000, v176
    v_mul_f32 v176, v176, v54
    v_cvt_pk_bf16_f32 v176, v176, v176
    v_sub_f32 v177, v177, v52
    v_cvt_pk_bf16_f32 v177, v177, v177
    v_and_b32 v177, 0xffff0000, v177
    v_mul_f32 v177, v177, v54
    v_cvt_pk_bf16_f32 v177, v177, v177
    v_sub_f32 v178, v178, v52
    v_cvt_pk_bf16_f32 v178, v178, v178
    v_and_b32 v178, 0xffff0000, v178
    v_mul_f32 v178, v178, v54
    v_cvt_pk_bf16_f32 v178, v178, v178
    v_sub_f32 v179, v179, v52
    v_cvt_pk_bf16_f32 v179, v179, v179
    v_and_b32 v179, 0xffff0000, v179
    v_mul_f32 v179, v179, v54
    v_cvt_pk_bf16_f32 v179, v179, v179
    v_sub_f32 v180, v180, v52
    v_cvt_pk_bf16_f32 v180, v180, v180
    v_and_b32 v180, 0xffff0000, v180
    v_mul_f32 v180, v180, v54
    v_cvt_pk_bf16_f32 v180, v180, v180
    v_sub_f32 v181, v181, v52
    v_cvt_pk_bf16_f32 v181, v181, v181
    v_and_b32 v181, 0xffff0000, v181
    v_mul_f32 v181, v181, v54
    v_cvt_pk_bf16_f32 v181, v181, v181
    v_sub_f32 v182, v182, v52
    v_cvt_pk_bf16_f32 v182, v182, v182
    v_and_b32 v182, 0xffff0000, v182
    v_mul_f32 v182, v182, v54
    v_cvt_pk_bf16_f32 v182, v182, v182
    v_sub_f32 v183, v183, v52
    v_cvt_pk_bf16_f32 v183, v183, v183
    v_and_b32 v183, 0xffff0000, v183
    v_mul_f32 v183, v183, v54
    v_cvt_pk_bf16_f32 v183, v183, v183
    ds_write_b32 v9, v174 offset:40448
    ds_write_b32 v9, v175 offset:40512
    ds_write_b32 v9, v176 offset:40576
    ds_write_b32 v9, v177 offset:40640
    ds_write_b32 v9, v178 offset:40704
    ds_write_b32 v9, v179 offset:40768
    ds_write_b32 v9, v180 offset:40832
    ds_write_b32 v9, v181 offset:40896
    ds_write_b32 v9, v182 offset:40960
    ds_write_b32 v9, v183 offset:41024
    v_lshrrev_b32 v9, 2, v1
    v_lshlrev_b32 v9, 2, v9
    v_add_u32 v9, v9, v2
    v_mul_u32_u24 v10, 640, v9
    s_mul_i32 s48, s55, 80
    s_add_u32 s48, s48, 32768
    v_add_u32 v10, s48, v10
    s_waitcnt lgkmcnt(0)
    ds_read_b128 v[184:187], v10 offset:0
    ds_read_b128 v[188:191], v10 offset:16
    ds_read_b128 v[192:195], v10 offset:32
    ds_read_b128 v[196:199], v10 offset:48
    ds_read_b128 v[200:203], v10 offset:64
    s_waitcnt lgkmcnt(0)
    v_and_b32 v20, v184, v44
    v_and_b32 v21, v184, v45
    s_nop 1
    v_mfma_f32_16x16x16_bf16 v[28:31], v[20:21], v[64:65], 0
    v_mfma_f32_16x16x16_bf16 v[32:35], v[20:21], v[66:67], 0
    v_and_b32 v22, v185, v44
    v_and_b32 v23, v185, v45
    s_nop 1
    v_mfma_f32_16x16x16_bf16 v[28:31], v[22:23], v[68:69], v[28:31]
    v_mfma_f32_16x16x16_bf16 v[32:35], v[22:23], v[70:71], v[32:35]
    v_and_b32 v20, v186, v44
    v_and_b32 v21, v186, v45
    s_nop 1
    v_mfma_f32_16x16x16_bf16 v[28:31], v[20:21], v[72:73], v[28:31]
    v_mfma_f32_16x16x16_bf16 v[32:35], v[20:21], v[74:75], v[32:35]
    v_and_b32 v22, v187, v44
    v_and_b32 v23, v187, v45
    s_nop 1
    v_mfma_f32_16x16x16_bf16 v[28:31], v[22:23], v[76:77], v[28:31]
    v_mfma_f32_16x16x16_bf16 v[32:35], v[22:23], v[78:79], v[32:35]
    v_and_b32 v20, v188, v44
    v_and_b32 v21, v188, v45
    s_nop 1
    v_mfma_f32_16x16x16_bf16 v[28:31], v[20:21], v[80:81], v[28:31]
    v_mfma_f32_16x16x16_bf16 v[32:35], v[20:21], v[82:83], v[32:35]
    v_and_b32 v22, v189, v44
    v_and_b32 v23, v189, v45
    s_nop 1
    v_mfma_f32_16x16x16_bf16 v[28:31], v[22:23], v[84:85], v[28:31]
    v_mfma_f32_16x16x16_bf16 v[32:35], v[22:23], v[86:87], v[32:35]
    v_and_b32 v20, v190, v44
    v_and_b32 v21, v190, v45
    s_nop 1
    v_mfma_f32_16x16x16_bf16 v[28:31], v[20:21], v[88:89], v[28:31]
    v_mfma_f32_16x16x16_bf16 v[32:35], v[20:21], v[90:91], v[32:35]
    v_and_b32 v22, v191, v44
    v_and_b32 v23, v191, v45
    s_nop 1
    v_mfma_f32_16x16x16_bf16 v[28:31], v[22:23], v[92:93], v[28:31]
    v_mfma_f32_16x16x16_bf16 v[32:35], v[22:23], v[94:95], v[32:35]
    v_and_b32 v20, v192, v44
    v_and_b32 v21, v192, v45
    s_nop 1
    v_mfma_f32_16x16x16_bf16 v[28:31], v[20:21], v[96:97], v[28:31]
    v_mfma_f32_16x16x16_bf16 v[32:35], v[20:21], v[98:99], v[32:35]
    v_and_b32 v22, v193, v44
    v_and_b32 v23, v193, v45
    s_nop 1
    v_mfma_f32_16x16x16_bf16 v[28:31], v[22:23], v[100:101], v[28:31]
    v_mfma_f32_16x16x16_bf16 v[32:35], v[22:23], v[102:103], v[32:35]
    v_and_b32 v20, v194, v44
    v_and_b32 v21, v194, v45
    s_nop 1
    v_mfma_f32_16x16x16_bf16 v[28:31], v[20:21], v[104:105], v[28:31]
    v_mfma_f32_16x16x16_bf16 v[32:35], v[20:21], v[106:107], v[32:35]
    v_and_b32 v22, v195, v44
    v_and_b32 v23, v195, v45
    s_nop 1
    v_mfma_f32_16x16x16_bf16 v[28:31], v[22:23], v[108:109], v[28:31]
    v_mfma_f32_16x16x16_bf16 v[32:35], v[22:23], v[110:111], v[32:35]
    v_and_b32 v20, v196, v44
    v_and_b32 v21, v196, v45
    s_nop 1
    v_mfma_f32_16x16x16_bf16 v[28:31], v[20:21], v[112:113], v[28:31]
    v_mfma_f32_16x16x16_bf16 v[32:35], v[20:21], v[114:115], v[32:35]
    v_and_b32 v22, v197, v44
    v_and_b32 v23, v197, v45
    s_nop 1
    v_mfma_f32_16x16x16_bf16 v[28:31], v[22:23], v[116:117], v[28:31]
    v_mfma_f32_16x16x16_bf16 v[32:35], v[22:23], v[118:119], v[32:35]
    v_and_b32 v20, v198, v44
    v_and_b32 v21, v198, v45
    s_nop 1
    v_mfma_f32_16x16x16_bf16 v[28:31], v[20:21], v[120:121], v[28:31]
    v_mfma_f32_16x16x16_bf16 v[32:35], v[20:21], v[122:123], v[32:35]
    v_and_b32 v22, v199, v44
    v_and_b32 v23, v199, v45
    s_nop 1
    v_mfma_f32_16x16x16_bf16 v[28:31], v[22:23], v[124:125], v[28:31]
    v_mfma_f32_16x16x16_bf16 v[32:35], v[22:23], v[126:127], v[32:35]
    v_and_b32 v20, v200, v44
    v_and_b32 v21, v200, v45
    s_nop 1
    v_mfma_f32_16x16x16_bf16 v[28:31], v[20:21], v[128:129], v[28:31]
    v_mfma_f32_16x16x16_bf16 v[32:35], v[20:21], v[130:131], v[32:35]
    v_and_b32 v22, v201, v44
    v_and_b32 v23, v201, v45
    s_nop 1
    v_mfma_f32_16x16x16_bf16 v[28:31], v[22:23], v[132:133], v[28:31]
    v_mfma_f32_16x16x16_bf16 v[32:35], v[22:23], v[134:135], v[32:35]
    v_and_b32 v20, v202, v44
    v_and_b32 v21, v202, v45
    s_nop 1
    v_mfma_f32_16x16x16_bf16 v[28:31], v[20:21], v[136:137], v[28:31]
    v_mfma_f32_16x16x16_bf16 v[32:35], v[20:21], v[138:139], v[32:35]
    v_and_b32 v22, v203, v44
    v_and_b32 v23, v203, v45
    s_nop 1
    v_mfma_f32_16x16x16_bf16 v[28:31], v[22:23], v[140:141], v[28:31]
    v_mfma_f32_16x16x16_bf16 v[32:35], v[22:23], v[142:143], v[32:35]
    v_mul_u32_u24 v12, 6912, v2
    v_lshlrev_b32 v13, 4, v1
    v_add_u32 v12, v12, v13
    s_mul_i32 s48, s55, 55296
    s_lshl_b32 s49, s54, 8
    s_add_u32 s48, s48, s49
    s_add_u32 s48, s48, 1769472
    s_add_u32 s49, s48, 27648
    s_nop 7
    buffer_store_dwordx4 v[28:31], v12, s[20:23], s48 offen sc1
    buffer_store_dwordx4 v[32:35], v12, s[20:23], s49 offen sc1
    s_waitcnt vmcnt(0)
    v_mov_b32 v52, 1
    s_mov_b64 exec, 1
    s_and_b32 s48, s2, 3
    s_lshl_b32 s48, s48, 6
    buffer_atomic_add v52, off, s[24:27], s48 sc1
    s_mov_b64 exec, -1
    s_branch L_wo_6
L_w5_7:
    s_cmp_eq_u32 s5, 1
    s_cbranch_scc0 L_wo_6
    v_mov_b32 v52, 1
    s_mov_b64 exec, 1
    s_and_b32 s48, s2, 3
    s_lshl_b32 s48, s48, 6
    buffer_atomic_add v52, off, s[24:27], s48 sc1
    s_mov_b64 exec, -1
L_wo_6:
    v_mul_u32_u24 v3, 1280, v2
    v_lshlrev_b32 v9, 4, v1
    v_add_u32 v3, v3, v9
    s_lshl_b32 s48, s45, 7
    s_lshl_b32 s49, s5, 5
    s_add_u32 s48, s48, s49
    s_mul_i32 s48, s48, 1280
    buffer_load_dwordx4 v[64:67], v3, s[16:19], s48 offen offset:0 nt
    buffer_load_dwordx4 v[68:71], v3, s[16:19], s48 offen offset:256 nt
    s_waitcnt vmcnt(1)
    buffer_load_dwordx4 v[72:75], v3, s[16:19], s48 offen offset:512 nt
    s_waitcnt vmcnt(1)
    buffer_load_dwordx4 v[76:79], v3, s[16:19], s48 offen offset:768 nt
    s_waitcnt vmcnt(1)
    buffer_load_dwordx4 v[80:83], v3, s[16:19], s48 offen offset:1024 nt
    s_add_u32 s48, s48, 5120
    s_waitcnt vmcnt(1)
    buffer_load_dwordx4 v[84:87], v3, s[16:19], s48 offen offset:0 nt
    s_waitcnt vmcnt(1)
    buffer_load_dwordx4 v[88:91], v3, s[16:19], s48 offen offset:256 nt
    s_waitcnt vmcnt(1)
    buffer_load_dwordx4 v[92:95], v3, s[16:19], s48 offen offset:512 nt
    s_waitcnt vmcnt(1)
    buffer_load_dwordx4 v[96:99], v3, s[16:19], s48 offen offset:768 nt
    s_waitcnt vmcnt(1)
    buffer_load_dwordx4 v[100:103], v3, s[16:19], s48 offen offset:1024 nt
    s_add_u32 s48, s48, 5120
    s_waitcnt vmcnt(1)
    buffer_load_dwordx4 v[104:107], v3, s[16:19], s48 offen offset:0 nt
    s_waitcnt vmcnt(1)
    buffer_load_dwordx4 v[108:111], v3, s[16:19], s48 offen offset:256 nt
    s_waitcnt vmcnt(1)
    buffer_load_dwordx4 v[112:115], v3, s[16:19], s48 offen offset:512 nt
    s_waitcnt vmcnt(1)
    buffer_load_dwordx4 v[116:119], v3, s[16:19], s48 offen offset:768 nt
    s_waitcnt vmcnt(1)
    buffer_load_dwordx4 v[120:123], v3, s[16:19], s48 offen offset:1024 nt
    s_add_u32 s48, s48, 5120
    s_waitcnt vmcnt(1)
    buffer_load_dwordx4 v[124:127], v3, s[16:19], s48 offen offset:0 nt
    s_waitcnt vmcnt(1)
    buffer_load_dwordx4 v[128:131], v3, s[16:19], s48 offen offset:256 nt
    s_waitcnt vmcnt(1)
    buffer_load_dwordx4 v[132:135], v3, s[16:19], s48 offen offset:512 nt
    s_waitcnt vmcnt(1)
    buffer_load_dwordx4 v[136:139], v3, s[16:19], s48 offen offset:768 nt
    s_waitcnt vmcnt(1)
    buffer_load_dwordx4 v[140:143], v3, s[16:19], s48 offen offset:1024 nt
    s_add_u32 s48, s48, 5120
    s_waitcnt vmcnt(1)
    buffer_load_dwordx4 v[144:147], v3, s[16:19], s48 offen offset:0 nt
    s_waitcnt vmcnt(1)
    buffer_load_dwordx4 v[148:151], v3, s[16:19], s48 offen offset:256 nt
    s_waitcnt vmcnt(1)
    buffer_load_dwordx4 v[152:155], v3, s[16:19], s48 offen offset:512 nt
    s_waitcnt vmcnt(1)
    buffer_load_dwordx4 v[156:159], v3, s[16:19], s48 offen offset:768 nt
    s_waitcnt vmcnt(1)
    buffer_load_dwordx4 v[160:163], v3, s[16:19], s48 offen offset:1024 nt
    s_add_u32 s48, s48, 5120
    s_waitcnt vmcnt(1)
    buffer_load_dwordx4 v[164:167], v3, s[16:19], s48 offen offset:0 nt
    s_waitcnt vmcnt(1)
    buffer_load_dwordx4 v[168:171], v3, s[16:19], s48 offen offset:256 nt
    s_waitcnt vmcnt(1)
    buffer_load_dwordx4 v[172:175], v3, s[16:19], s48 offen offset:512 nt
    s_waitcnt vmcnt(1)
    buffer_load_dwordx4 v[176:179], v3, s[16:19], s48 offen offset:768 nt
    s_waitcnt vmcnt(1)
    buffer_load_dwordx4 v[180:183], v3, s[16:19], s48 offen offset:1024 nt
    s_add_u32 s48, s48, 5120
    s_waitcnt vmcnt(1)
    buffer_load_dwordx4 v[184:187], v3, s[16:19], s48 offen offset:0 nt
    s_waitcnt vmcnt(1)
    buffer_load_dwordx4 v[188:191], v3, s[16:19], s48 offen offset:256 nt
    s_waitcnt vmcnt(1)
    buffer_load_dwordx4 v[192:195], v3, s[16:19], s48 offen offset:512 nt
    s_waitcnt vmcnt(1)
    buffer_load_dwordx4 v[196:199], v3, s[16:19], s48 offen offset:768 nt
    s_waitcnt vmcnt(1)
    buffer_load_dwordx4 v[200:203], v3, s[16:19], s48 offen offset:1024 nt
    s_add_u32 s48, s48, 5120
    s_waitcnt vmcnt(1)
    buffer_load_dwordx4 v[204:207], v3, s[16:19], s48 offen offset:0 nt
    s_waitcnt vmcnt(1)
    buffer_load_dwordx4 v[208:211], v3, s[16:19], s48 offen offset:256 nt
    s_waitcnt vmcnt(1)
    buffer_load_dwordx4 v[212:215], v3, s[16:19], s48 offen offset:512 nt
    s_waitcnt vmcnt(1)
    buffer_load_dwordx4 v[216:219], v3, s[16:19], s48 offen offset:768 nt
    s_waitcnt vmcnt(1)
    buffer_load_dwordx4 v[220:223], v3, s[16:19], s48 offen offset:1024 nt
    s_cmp_eq_u32 s5, 0
    s_cbranch_scc0 L_toB2_10
    s_mov_b32 s48, 200000
L_mw_11:
    v_mov_b32 v9, 2048
    ds_read_b128 v[52:55], v9
    s_waitcnt lgkmcnt(0)
    v_max3_u32 v9, v52, v53, v54
    v_max_u32 v9, v9, v55
    v_cmp_eq_u32 vcc, -1, v9
    s_cbranch_vccz L_mw_done_12
    s_sub_u32 s48, s48, 1
    s_cmp_lg_u32 s48, 0
    s_cbranch_scc1 L_mw_11
L_mw_done_12:
    v_max3_f32 v56, v52, v53, v54
    v_max_f32 v56, v56, v55
    v_lshlrev_b32 v9, 4, v0
    v_add_u32 v9, 16384, v9
    v_mov_b32 v57, 0
    s_mov_b32 s48, 4
L_lsum_13:
    ds_read_b128 v[224:227], v9 offset:0
    ds_read_b128 v[228:231], v9 offset:1024
    ds_read_b128 v[232:235], v9 offset:2048
    ds_read_b128 v[236:239], v9 offset:3072
    v_add_u32 v9, 4096, v9
    s_waitcnt lgkmcnt(0)
    v_sub_f32 v224, v224, v56
    v_sub_f32 v225, v225, v56
    v_sub_f32 v226, v226, v56
    v_sub_f32 v227, v227, v56
    v_sub_f32 v228, v228, v56
    v_sub_f32 v229, v229, v56
    v_sub_f32 v230, v230, v56
    v_sub_f32 v231, v231, v56
    v_sub_f32 v232, v232, v56
    v_sub_f32 v233, v233, v56
    v_sub_f32 v234, v234, v56
    v_sub_f32 v235, v235, v56
    v_sub_f32 v236, v236, v56
    v_sub_f32 v237, v237, v56
    v_sub_f32 v238, v238, v56
    v_sub_f32 v239, v239, v56
    v_mul_f32 v224, 0x3fb8aa3b, v224
    v_mul_f32 v225, 0x3fb8aa3b, v225
    v_mul_f32 v226, 0x3fb8aa3b, v226
    v_mul_f32 v227, 0x3fb8aa3b, v227
    v_mul_f32 v228, 0x3fb8aa3b, v228
    v_mul_f32 v229, 0x3fb8aa3b, v229
    v_mul_f32 v230, 0x3fb8aa3b, v230
    v_mul_f32 v231, 0x3fb8aa3b, v231
    v_mul_f32 v232, 0x3fb8aa3b, v232
    v_mul_f32 v233, 0x3fb8aa3b, v233
    v_mul_f32 v234, 0x3fb8aa3b, v234
    v_mul_f32 v235, 0x3fb8aa3b, v235
    v_mul_f32 v236, 0x3fb8aa3b, v236
    v_mul_f32 v237, 0x3fb8aa3b, v237
    v_mul_f32 v238, 0x3fb8aa3b, v238
    v_mul_f32 v239, 0x3fb8aa3b, v239
    v_exp_f32 v224, v224
    v_exp_f32 v225, v225
    v_exp_f32 v226, v226
    v_exp_f32 v227, v227
    v_exp_f32 v228, v228
    v_exp_f32 v229, v229
    v_exp_f32 v230, v230
    v_exp_f32 v231, v231
    v_exp_f32 v232, v232
    v_exp_f32 v233, v233
    v_exp_f32 v234, v234
    v_exp_f32 v235, v235
    v_exp_f32 v236, v236
    v_exp_f32 v237, v237
    v_exp_f32 v238, v238
    v_exp_f32 v239, v239
    s_nop 0
    v_add_f32 v57, v57, v224
    v_add_f32 v57, v57, v225
    v_add_f32 v57, v57, v226
    v_add_f32 v57, v57, v227
    v_add_f32 v57, v57, v228
    v_add_f32 v57, v57, v229
    v_add_f32 v57, v57, v230
    v_add_f32 v57, v57, v231
    v_add_f32 v57, v57, v232
    v_add_f32 v57, v57, v233
    v_add_f32 v57, v57, v234
    v_add_f32 v57, v57, v235
    v_add_f32 v57, v57, v236
    v_add_f32 v57, v57, v237
    v_add_f32 v57, v57, v238
    v_add_f32 v57, v57, v239
    s_sub_u32 s48, s48, 1
    s_cmp_lg_u32 s48, 0
    s_cbranch_scc1 L_lsum_13
    s_nop 1
    v_add_f32_dpp v57, v57, v57 row_ror:8 row_mask:0xf bank_mask:0xf
    s_nop 1
    v_add_f32_dpp v57, v57, v57 row_ror:4 row_mask:0xf bank_mask:0xf
    s_nop 1
    v_add_f32_dpp v57, v57, v57 row_ror:2 row_mask:0xf bank_mask:0xf
    s_nop 1
    v_add_f32_dpp v57, v57, v57 row_ror:1 row_mask:0xf bank_mask:0xf
    s_nop 1
    v_add_f32_dpp v57, v57, v57 row_bcast:15 row_mask:0xa bank_mask:0xf
    s_nop 1
    v_add_f32_dpp v57, v57, v57 row_bcast:31 row_mask:0xc bank_mask:0xf
    s_nop 1
    v_readlane_b32 s50, v57, 63
    s_nop 1
    v_mov_b32 v57, s50
    s_lshl_b32 s49, s47, 7
    s_add_u32 s49, s49, 1703936
    v_mov_b32 v9, 0
    s_mov_b64 exec, 1
    buffer_store_dwordx2 v[56:57], v9, s[20:23], s49 offen sc1
    s_mov_b64 exec, -1
    s_mov_b32 s40, s80
    s_mov_b32 s41, s81
    s_mov_b32 s42, 0x21c000
    s_mov_b32 s43, 0x20000
    s_load_dword s48, s[84:85], 0x0
    s_load_dword s49, s[84:85], 0x40
    s_load_dword s50, s[84:85], 0x80
    s_load_dword s51, s[84:85], 0xc0
    s_waitcnt lgkmcnt(0)
    s_min_u32 s48, s48, s49
    s_min_u32 s50, s50, s51
    s_min_u32 s48, s48, s50
    s_cmp_ge_u32 s48, 64
    s_cbranch_scc1 L_chkfast_14
    v_and_b32 v59, 3, v0
    v_lshlrev_b32 v59, 6, v59
    s_mov_b32 s48, 200000
L_zc_15:
    buffer_load_dword v58, v59, s[24:27], 0 offen sc1
    s_waitcnt vmcnt(0)
    v_cmp_gt_u32 vcc, 64, v58
    s_cbranch_vccz L_zc_done_16
    s_sub_u32 s48, s48, 1
    s_cmp_lg_u32 s48, 0
    s_cbranch_scc1 L_zc_15
L_zc_done_16:
L_chkfast_14:
    s_lshl_b32 s54, s45, 1
    s_add_u32 s54, s54, s46
    s_mul_i32 s54, s54, 27
    v_lshrrev_b32 v58, 2, v0
    v_mul_u32_u24 v58, 27648, v58
    v_and_b32 v59, 3, v0
    v_lshlrev_b32 v60, 5, v59
    v_add_u32 v58, v58, v60
    s_mul_i32 s48, s44, 6912
    s_lshl_b32 s49, s54, 2
    s_add_u32 s48, s48, s49
    s_add_u32 s48, s48, 1769472
    buffer_load_dwordx4 v[224:227], v58, s[20:23], s48 offen sc1
    buffer_load_dwordx4 v[228:231], v58, s[20:23], s48 offen offset:16 sc1
    s_waitcnt vmcnt(0)
    s_nop 1
    v_add_f32_dpp v224, v224, v224 row_ror:8 row_mask:0xf bank_mask:0xf
    v_add_f32_dpp v225, v225, v225 row_ror:8 row_mask:0xf bank_mask:0xf
    v_add_f32_dpp v226, v226, v226 row_ror:8 row_mask:0xf bank_mask:0xf
    v_add_f32_dpp v227, v227, v227 row_ror:8 row_mask:0xf bank_mask:0xf
    v_add_f32_dpp v228, v228, v228 row_ror:8 row_mask:0xf bank_mask:0xf
    v_add_f32_dpp v229, v229, v229 row_ror:8 row_mask:0xf bank_mask:0xf
    v_add_f32_dpp v230, v230, v230 row_ror:8 row_mask:0xf bank_mask:0xf
    v_add_f32_dpp v231, v231, v231 row_ror:8 row_mask:0xf bank_mask:0xf
    v_mov_b32 v232, v224
    v_mov_b32 v233, v225
    v_mov_b32 v234, v226
    v_mov_b32 v235, v227
    v_mov_b32 v236, v228
    v_mov_b32 v237, v229
    v_mov_b32 v238, v230
    v_mov_b32 v239, v231
    s_nop 1
    v_permlane16_swap_b32 v232, v224
    v_permlane16_swap_b32 v233, v225
    v_permlane16_swap_b32 v234, v226
    v_permlane16_swap_b32 v235, v227
    v_permlane16_swap_b32 v236, v228
    v_permlane16_swap_b32 v237, v229
    v_permlane16_swap_b32 v238, v230
    v_permlane16_swap_b32 v239, v231
    s_nop 1
    v_add_f32 v224, v224, v232
    v_add_f32 v225, v225, v233
    v_add_f32 v226, v226, v234
    v_add_f32 v227, v227, v235
    v_add_f32 v228, v228, v236
    v_add_f32 v229, v229, v237
    v_add_f32 v230, v230, v238
    v_add_f32 v231, v231, v239
    v_mov_b32 v232, v224
    v_mov_b32 v233, v225
    v_mov_b32 v234, v226
    v_mov_b32 v235, v227
    v_mov_b32 v236, v228
    v_mov_b32 v237, v229
    v_mov_b32 v238, v230
    v_mov_b32 v239, v231
    s_nop 1
    v_permlane32_swap_b32 v232, v224
    v_permlane32_swap_b32 v233, v225
    v_permlane32_swap_b32 v234, v226
    v_permlane32_swap_b32 v235, v227
    v_permlane32_swap_b32 v236, v228
    v_permlane32_swap_b32 v237, v229
    v_permlane32_swap_b32 v238, v230
    v_permlane32_swap_b32 v239, v231
    s_nop 1
    v_add_f32 v224, v224, v232
    v_add_f32 v225, v225, v233
    v_add_f32 v226, v226, v234
    v_add_f32 v227, v227, v235
    v_add_f32 v228, v228, v236
    v_add_f32 v229, v229, v237
    v_add_f32 v230, v230, v238
    v_add_f32 v231, v231, v239
    v_cvt_pk_bf16_f32 v224, v224, v224
    v_and_b32 v224, 0xffff0000, v224
    v_cvt_pk_bf16_f32 v225, v225, v225
    v_and_b32 v225, 0xffff0000, v225
    v_cvt_pk_bf16_f32 v226, v226, v226
    v_and_b32 v226, 0xffff0000, v226
    v_cvt_pk_bf16_f32 v227, v227, v227
    v_and_b32 v227, 0xffff0000, v227
    v_cvt_pk_bf16_f32 v228, v228, v228
    v_and_b32 v228, 0xffff0000, v228
    v_cvt_pk_bf16_f32 v229, v229, v229
    v_and_b32 v229, 0xffff0000, v229
    v_cvt_pk_bf16_f32 v230, v230, v230
    v_and_b32 v230, 0xffff0000, v230
    v_cvt_pk_bf16_f32 v231, v231, v231
    v_and_b32 v231, 0xffff0000, v231
    s_nop 1
    v_mov_b32_dpp v232, v224 row_ror:12 row_mask:0xf bank_mask:0xf
    v_mov_b32_dpp v233, v225 row_ror:12 row_mask:0xf bank_mask:0xf
    v_mov_b32_dpp v234, v226 row_ror:12 row_mask:0xf bank_mask:0xf
    v_mov_b32_dpp v235, v227 row_ror:12 row_mask:0xf bank_mask:0xf
    v_mov_b32_dpp v236, v228 row_ror:12 row_mask:0xf bank_mask:0xf
    v_mov_b32_dpp v237, v229 row_ror:12 row_mask:0xf bank_mask:0xf
    v_mov_b32_dpp v238, v230 row_ror:12 row_mask:0xf bank_mask:0xf
    v_mov_b32_dpp v239, v231 row_ror:12 row_mask:0xf bank_mask:0xf
    v_max_f32 v224, 0, v224
    v_mul_f32 v224, v224, v232
    v_cvt_pk_bf16_f32 v224, v224, v224
    v_max_f32 v225, 0, v225
    v_mul_f32 v225, v225, v233
    v_cvt_pk_bf16_f32 v225, v225, v225
    v_max_f32 v226, 0, v226
    v_mul_f32 v226, v226, v234
    v_cvt_pk_bf16_f32 v226, v226, v226
    v_max_f32 v227, 0, v227
    v_mul_f32 v227, v227, v235
    v_cvt_pk_bf16_f32 v227, v227, v227
    v_max_f32 v228, 0, v228
    v_mul_f32 v228, v228, v236
    v_cvt_pk_bf16_f32 v228, v228, v228
    v_max_f32 v229, 0, v229
    v_mul_f32 v229, v229, v237
    v_cvt_pk_bf16_f32 v229, v229, v229
    v_max_f32 v230, 0, v230
    v_mul_f32 v230, v230, v238
    v_cvt_pk_bf16_f32 v230, v230, v230
    v_max_f32 v231, 0, v231
    v_mul_f32 v231, v231, v239
    v_cvt_pk_bf16_f32 v231, v231, v231
    v_cmp_gt_u32 vcc, 3, v59
    s_nop 1
    v_cndmask_b32 v227, 0, v227, vcc
    v_cndmask_b32 v228, 0, v228, vcc
    v_cndmask_b32 v229, 0, v229, vcc
    v_cndmask_b32 v230, 0, v230, vcc
    v_cndmask_b32 v231, 0, v231, vcc
    v_add_u32 v60, 43008, v60
    s_mov_b64 exec, 15
    ds_write_b128 v60, v[224:227]
    ds_write_b128 v60, v[228:231] offset:16
    s_mov_b64 exec, -1
    s_waitcnt lgkmcnt(0)
    v_and_b32 v60, 7, v1
    v_lshlrev_b32 v60, 2, v60
    v_add_u32 v60, v60, v2
    v_lshlrev_b32 v60, 2, v60
    v_add_u32 v60, 43008, v60
    ds_read_b32 v61, v60
    v_mul_u32_u24 v58, 1280, v2
    v_lshlrev_b32 v59, 4, v1
    v_add_u32 v58, v58, v59
    s_mul_i32 s48, s54, 1280
    buffer_load_dwordx4 v[224:227], v58, s[40:43], s48 offen offset:0 nt
    buffer_load_dwordx4 v[228:231], v58, s[40:43], s48 offen offset:256 nt
    buffer_load_dwordx4 v[232:235], v58, s[40:43], s48 offen offset:512 nt
    buffer_load_dwordx4 v[236:239], v58, s[40:43], s48 offen offset:768 nt
    buffer_load_dwordx4 v[240:243], v58, s[40:43], s48 offen offset:1024 nt
    s_add_u32 s48, s48, 5120
    s_waitcnt lgkmcnt(0)
    v_and_b32_dpp v20, v61, v4 row_newbcast:0 row_mask:0xf bank_mask:0xf
    v_and_b32_dpp v21, v61, v5 row_newbcast:0 row_mask:0xf bank_mask:0xf
    v_and_b32_dpp v22, v61, v6 row_newbcast:0 row_mask:0xf bank_mask:0xf
    v_and_b32_dpp v23, v61, v7 row_newbcast:0 row_mask:0xf bank_mask:0xf
    s_nop 1
    s_waitcnt vmcnt(4)
    v_mfma_f32_16x16x32_bf16 v[32:35], v[20:23], v[224:227], 0
    s_waitcnt vmcnt(3)
    v_mfma_f32_16x16x32_bf16 v[36:39], v[20:23], v[228:231], 0
    s_waitcnt vmcnt(2)
    v_mfma_f32_16x16x32_bf16 v[40:43], v[20:23], v[232:235], 0
    s_waitcnt vmcnt(1)
    v_mfma_f32_16x16x32_bf16 v[44:47], v[20:23], v[236:239], 0
    s_waitcnt vmcnt(0)
    v_mfma_f32_16x16x32_bf16 v[48:51], v[20:23], v[240:243], 0
    s_nop 7
    buffer_load_dwordx4 v[224:227], v58, s[40:43], s48 offen offset:0 nt
    buffer_load_dwordx4 v[228:231], v58, s[40:43], s48 offen offset:256 nt
    buffer_load_dwordx4 v[232:235], v58, s[40:43], s48 offen offset:512 nt
    buffer_load_dwordx4 v[236:239], v58, s[40:43], s48 offen offset:768 nt
    buffer_load_dwordx4 v[240:243], v58, s[40:43], s48 offen offset:1024 nt
    s_add_u32 s48, s48, 5120
    v_and_b32_dpp v24, v61, v4 row_newbcast:1 row_mask:0xf bank_mask:0xf
    v_and_b32_dpp v25, v61, v5 row_newbcast:1 row_mask:0xf bank_mask:0xf
    v_and_b32_dpp v26, v61, v6 row_newbcast:1 row_mask:0xf bank_mask:0xf
    v_and_b32_dpp v27, v61, v7 row_newbcast:1 row_mask:0xf bank_mask:0xf
    s_nop 1
    s_waitcnt vmcnt(4)
    v_mfma_f32_16x16x32_bf16 v[32:35], v[24:27], v[224:227], v[32:35]
    s_waitcnt vmcnt(3)
    v_mfma_f32_16x16x32_bf16 v[36:39], v[24:27], v[228:231], v[36:39]
    s_waitcnt vmcnt(2)
    v_mfma_f32_16x16x32_bf16 v[40:43], v[24:27], v[232:235], v[40:43]
    s_waitcnt vmcnt(1)
    v_mfma_f32_16x16x32_bf16 v[44:47], v[24:27], v[236:239], v[44:47]
    s_waitcnt vmcnt(0)
    v_mfma_f32_16x16x32_bf16 v[48:51], v[24:27], v[240:243], v[48:51]
    s_nop 7
    buffer_load_dwordx4 v[224:227], v58, s[40:43], s48 offen offset:0 nt
    buffer_load_dwordx4 v[228:231], v58, s[40:43], s48 offen offset:256 nt
    buffer_load_dwordx4 v[232:235], v58, s[40:43], s48 offen offset:512 nt
    buffer_load_dwordx4 v[236:239], v58, s[40:43], s48 offen offset:768 nt
    buffer_load_dwordx4 v[240:243], v58, s[40:43], s48 offen offset:1024 nt
    s_add_u32 s48, s48, 5120
    v_and_b32_dpp v20, v61, v4 row_newbcast:2 row_mask:0xf bank_mask:0xf
    v_and_b32_dpp v21, v61, v5 row_newbcast:2 row_mask:0xf bank_mask:0xf
    v_and_b32_dpp v22, v61, v6 row_newbcast:2 row_mask:0xf bank_mask:0xf
    v_and_b32_dpp v23, v61, v7 row_newbcast:2 row_mask:0xf bank_mask:0xf
    s_nop 1
    s_waitcnt vmcnt(4)
    v_mfma_f32_16x16x32_bf16 v[32:35], v[20:23], v[224:227], v[32:35]
    s_waitcnt vmcnt(3)
    v_mfma_f32_16x16x32_bf16 v[36:39], v[20:23], v[228:231], v[36:39]
    s_waitcnt vmcnt(2)
    v_mfma_f32_16x16x32_bf16 v[40:43], v[20:23], v[232:235], v[40:43]
    s_waitcnt vmcnt(1)
    v_mfma_f32_16x16x32_bf16 v[44:47], v[20:23], v[236:239], v[44:47]
    s_waitcnt vmcnt(0)
    v_mfma_f32_16x16x32_bf16 v[48:51], v[20:23], v[240:243], v[48:51]
    s_nop 7
    buffer_load_dwordx4 v[224:227], v58, s[40:43], s48 offen offset:0 nt
    buffer_load_dwordx4 v[228:231], v58, s[40:43], s48 offen offset:256 nt
    buffer_load_dwordx4 v[232:235], v58, s[40:43], s48 offen offset:512 nt
    buffer_load_dwordx4 v[236:239], v58, s[40:43], s48 offen offset:768 nt
    buffer_load_dwordx4 v[240:243], v58, s[40:43], s48 offen offset:1024 nt
    s_add_u32 s48, s48, 5120
    v_and_b32_dpp v24, v61, v4 row_newbcast:3 row_mask:0xf bank_mask:0xf
    v_and_b32_dpp v25, v61, v5 row_newbcast:3 row_mask:0xf bank_mask:0xf
    v_and_b32_dpp v26, v61, v6 row_newbcast:3 row_mask:0xf bank_mask:0xf
    v_and_b32_dpp v27, v61, v7 row_newbcast:3 row_mask:0xf bank_mask:0xf
    s_nop 1
    s_waitcnt vmcnt(4)
    v_mfma_f32_16x16x32_bf16 v[32:35], v[24:27], v[224:227], v[32:35]
    s_waitcnt vmcnt(3)
    v_mfma_f32_16x16x32_bf16 v[36:39], v[24:27], v[228:231], v[36:39]
    s_waitcnt vmcnt(2)
    v_mfma_f32_16x16x32_bf16 v[40:43], v[24:27], v[232:235], v[40:43]
    s_waitcnt vmcnt(1)
    v_mfma_f32_16x16x32_bf16 v[44:47], v[24:27], v[236:239], v[44:47]
    s_waitcnt vmcnt(0)
    v_mfma_f32_16x16x32_bf16 v[48:51], v[24:27], v[240:243], v[48:51]
    s_nop 7
    buffer_load_dwordx4 v[224:227], v58, s[40:43], s48 offen offset:0 nt
    buffer_load_dwordx4 v[228:231], v58, s[40:43], s48 offen offset:256 nt
    buffer_load_dwordx4 v[232:235], v58, s[40:43], s48 offen offset:512 nt
    buffer_load_dwordx4 v[236:239], v58, s[40:43], s48 offen offset:768 nt
    buffer_load_dwordx4 v[240:243], v58, s[40:43], s48 offen offset:1024 nt
    s_add_u32 s48, s48, 5120
    v_and_b32_dpp v20, v61, v4 row_newbcast:4 row_mask:0xf bank_mask:0xf
    v_and_b32_dpp v21, v61, v5 row_newbcast:4 row_mask:0xf bank_mask:0xf
    v_and_b32_dpp v22, v61, v6 row_newbcast:4 row_mask:0xf bank_mask:0xf
    v_and_b32_dpp v23, v61, v7 row_newbcast:4 row_mask:0xf bank_mask:0xf
    s_nop 1
    s_waitcnt vmcnt(4)
    v_mfma_f32_16x16x32_bf16 v[32:35], v[20:23], v[224:227], v[32:35]
    s_waitcnt vmcnt(3)
    v_mfma_f32_16x16x32_bf16 v[36:39], v[20:23], v[228:231], v[36:39]
    s_waitcnt vmcnt(2)
    v_mfma_f32_16x16x32_bf16 v[40:43], v[20:23], v[232:235], v[40:43]
    s_waitcnt vmcnt(1)
    v_mfma_f32_16x16x32_bf16 v[44:47], v[20:23], v[236:239], v[44:47]
    s_waitcnt vmcnt(0)
    v_mfma_f32_16x16x32_bf16 v[48:51], v[20:23], v[240:243], v[48:51]
    s_nop 7
    buffer_load_dwordx4 v[224:227], v58, s[40:43], s48 offen offset:0 nt
    buffer_load_dwordx4 v[228:231], v58, s[40:43], s48 offen offset:256 nt
    buffer_load_dwordx4 v[232:235], v58, s[40:43], s48 offen offset:512 nt
    buffer_load_dwordx4 v[236:239], v58, s[40:43], s48 offen offset:768 nt
    buffer_load_dwordx4 v[240:243], v58, s[40:43], s48 offen offset:1024 nt
    s_add_u32 s48, s48, 5120
    v_and_b32_dpp v24, v61, v4 row_newbcast:5 row_mask:0xf bank_mask:0xf
    v_and_b32_dpp v25, v61, v5 row_newbcast:5 row_mask:0xf bank_mask:0xf
    v_and_b32_dpp v26, v61, v6 row_newbcast:5 row_mask:0xf bank_mask:0xf
    v_and_b32_dpp v27, v61, v7 row_newbcast:5 row_mask:0xf bank_mask:0xf
    s_nop 1
    s_waitcnt vmcnt(4)
    v_mfma_f32_16x16x32_bf16 v[32:35], v[24:27], v[224:227], v[32:35]
    s_waitcnt vmcnt(3)
    v_mfma_f32_16x16x32_bf16 v[36:39], v[24:27], v[228:231], v[36:39]
    s_waitcnt vmcnt(2)
    v_mfma_f32_16x16x32_bf16 v[40:43], v[24:27], v[232:235], v[40:43]
    s_waitcnt vmcnt(1)
    v_mfma_f32_16x16x32_bf16 v[44:47], v[24:27], v[236:239], v[44:47]
    s_waitcnt vmcnt(0)
    v_mfma_f32_16x16x32_bf16 v[48:51], v[24:27], v[240:243], v[48:51]
    s_nop 7
    buffer_load_dwordx4 v[224:227], v58, s[40:43], s48 offen offset:0 nt
    buffer_load_dwordx4 v[228:231], v58, s[40:43], s48 offen offset:256 nt
    buffer_load_dwordx4 v[232:235], v58, s[40:43], s48 offen offset:512 nt
    buffer_load_dwordx4 v[236:239], v58, s[40:43], s48 offen offset:768 nt
    buffer_load_dwordx4 v[240:243], v58, s[40:43], s48 offen offset:1024 nt
    v_and_b32_dpp v20, v61, v4 row_newbcast:6 row_mask:0xf bank_mask:0xf
    v_and_b32_dpp v21, v61, v5 row_newbcast:6 row_mask:0xf bank_mask:0xf
    v_and_b32_dpp v22, v61, v6 row_newbcast:6 row_mask:0xf bank_mask:0xf
    v_and_b32_dpp v23, v61, v7 row_newbcast:6 row_mask:0xf bank_mask:0xf
    s_nop 1
    s_waitcnt vmcnt(4)
    v_mfma_f32_16x16x32_bf16 v[32:35], v[20:23], v[224:227], v[32:35]
    s_waitcnt vmcnt(3)
    v_mfma_f32_16x16x32_bf16 v[36:39], v[20:23], v[228:231], v[36:39]
    s_waitcnt vmcnt(2)
    v_mfma_f32_16x16x32_bf16 v[40:43], v[20:23], v[232:235], v[40:43]
    s_waitcnt vmcnt(1)
    v_mfma_f32_16x16x32_bf16 v[44:47], v[20:23], v[236:239], v[44:47]
    s_waitcnt vmcnt(0)
    v_mfma_f32_16x16x32_bf16 v[48:51], v[20:23], v[240:243], v[48:51]
    s_nop 7
    s_xor_b32 s49, s47, 1
    s_lshl_b32 s49, s49, 7
    s_add_u32 s49, s49, 1703936
    v_mov_b32 v9, 0
    s_mov_b32 s48, 200000
L_ml_17:
    buffer_load_dwordx2 v[58:59], v9, s[20:23], s49 offen sc1
    s_waitcnt vmcnt(0)
    v_max_u32 v60, v58, v59
    v_cmp_eq_u32 vcc, -1, v60
    s_cbranch_vccz L_ml_done_18
    s_sub_u32 s48, s48, 1
    s_cmp_lg_u32 s48, 0
    s_cbranch_scc1 L_ml_17
L_ml_done_18:
    v_max_f32 v60, v56, v58
    v_sub_f32 v56, v56, v60
    v_sub_f32 v58, v58, v60
    v_sub_f32 v52, v52, v60
    v_sub_f32 v53, v53, v60
    v_sub_f32 v54, v54, v60
    v_sub_f32 v55, v55, v60
    v_mul_f32 v56, 0x3fb8aa3b, v56
    v_mul_f32 v58, 0x3fb8aa3b, v58
    v_mul_f32 v52, 0x3fb8aa3b, v52
    v_mul_f32 v53, 0x3fb8aa3b, v53
    v_mul_f32 v54, 0x3fb8aa3b, v54
    v_mul_f32 v55, 0x3fb8aa3b, v55
    v_exp_f32 v56, v56
    v_exp_f32 v58, v58
    v_exp_f32 v52, v52
    v_exp_f32 v53, v53
    v_exp_f32 v54, v54
    v_exp_f32 v55, v55
    v_mul_f32 v57, v57, v56
    v_fmac_f32 v57, v59, v58
    v_rcp_f32 v57, v57
    s_nop 0
    v_mul_f32 v52, v52, v57
    v_mul_f32 v53, v53, v57
    v_mul_f32 v54, v54, v57
    v_mul_f32 v55, v55, v57
    v_mov_b32 v9, 2064
    ds_write_b128 v9, v[52:55]
    s_waitcnt lgkmcnt(0)
    s_cmp_lt_u32 s2, 80
    s_cbranch_scc0 L_nored_19
    s_mul_i32 s62, s2, 205
    s_lshr_b32 s62, s62, 12
    s_mul_i32 s63, s62, 20
    s_sub_u32 s63, s2, s63
    v_and_b32 v59, 7, v0
    s_mul_i32 s48, s62, 1280
    s_lshl_b32 s49, s63, 6
    s_add_u32 s48, s48, s49
    v_lshlrev_b32 v61, 3, v59
    buffer_load_dwordx2 v[246:247], v61, s[8:11], s48 offen
    s_waitcnt vmcnt(0)
    v_lshlrev_b32 v244, 16, v246
    v_and_b32 v245, 0xffff0000, v246
    v_lshlrev_b32 v246, 16, v247
    v_and_b32 v247, 0xffff0000, v247
L_nored_19:
    s_branch L_toB2b_20
L_toB2_10:
    v_mov_b32 v32, 0
    v_mov_b32 v33, 0
    v_mov_b32 v34, 0
    v_mov_b32 v35, 0
    v_mov_b32 v36, 0
    v_mov_b32 v37, 0
    v_mov_b32 v38, 0
    v_mov_b32 v39, 0
    v_mov_b32 v40, 0
    v_mov_b32 v41, 0
    v_mov_b32 v42, 0
    v_mov_b32 v43, 0
    v_mov_b32 v44, 0
    v_mov_b32 v45, 0
    v_mov_b32 v46, 0
    v_mov_b32 v47, 0
    v_mov_b32 v48, 0
    v_mov_b32 v49, 0
    v_mov_b32 v50, 0
    v_mov_b32 v51, 0
    s_cmp_eq_u32 s5, 2
    s_cbranch_scc0 L_toB2b_20
    s_mov_b32 s48, 200000
L_mw6_21:
    v_mov_b32 v9, 2048
    ds_read_b128 v[52:55], v9
    s_waitcnt lgkmcnt(0)
    v_max3_u32 v9, v52, v53, v54
    v_max_u32 v9, v9, v55
    v_cmp_eq_u32 vcc, -1, v9
    s_cbranch_vccz L_mw6_done_22
    s_sub_u32 s48, s48, 1
    s_cmp_lg_u32 s48, 0
    s_cbranch_scc1 L_mw6_21
L_mw6_done_22:
    s_load_dword s48, s[84:85], 0x0
    s_load_dword s49, s[84:85], 0x40
    s_load_dword s50, s[84:85], 0x80
    s_load_dword s51, s[84:85], 0xc0
    s_waitcnt lgkmcnt(0)
    s_min_u32 s48, s48, s49
    s_min_u32 s50, s50, s51
    s_min_u32 s48, s48, s50
    s_cmp_ge_u32 s48, 64
    s_cbranch_scc1 L_chkfast_23
    v_and_b32 v59, 3, v0
    v_lshlrev_b32 v59, 6, v59
    s_mov_b32 s48, 200000
L_clr6_24:
    buffer_load_dword v58, v59, s[24:27], 0 offen sc1
    s_waitcnt vmcnt(0)
    v_cmp_gt_u32 vcc, 64, v58
    s_cbranch_vccz L_clr6_done_25
    s_sub_u32 s48, s48, 1
    s_cmp_lg_u32 s48, 0
    s_cbranch_scc1 L_clr6_24
L_clr6_done_25:
L_chkfast_23:
    s_lshr_b32 s49, s2, 3
    s_and_b32 s50, s2, 7
    s_lshl_b32 s50, s50, 8
    s_add_u32 s50, s50, 2621440
    s_lshl_b32 s49, s49, 2
    s_add_u32 s49, s49, s50
    v_and_b32 v52, 3, v0
    v_lshlrev_b32 v53, 2, v52
    v_add_u32 v53, 2304, v53
    v_lshlrev_b32 v52, 8, v52
    v_add_u32 v52, 3072, v52
    v_lshlrev_b32 v54, 2, v0
    v_min_u32 v54, 128, v54
    v_mov_b32 v9, 0
    s_mov_b32 s51, 0
    s_mov_b32 s58, 0
    s_mov_b32 s59, 0
    s_and_b32 s57, s2, 7
    s_lshl_b32 s57, s57, 8
    s_add_u32 s57, s57, 262144
    s_lshr_b32 s35, s2, 3
    s_mul_i32 s35, s35, 4
    s_sub_u32 s35, 200000, s35
    s_mov_b32 s48, 200000
L_mon_26:
    ds_read_b32 v55, v52
    s_waitcnt lgkmcnt(0)
    v_add_u32_dpp v56, v55, v55 quad_perm:[1,0,3,2] row_mask:0xf bank_mask:0xf
    s_nop 1
    v_add_u32_dpp v56, v56, v56 quad_perm:[2,3,0,1] row_mask:0xf bank_mask:0xf
    s_nop 1
    v_readfirstlane_b32 s52, v56
    s_nop 1
    s_cmp_ge_u32 s52, 960
    s_cbranch_scc1 L_mon_done_27
    s_mov_b64 exec, 1
    buffer_store_dword v56, v9, s[20:23], s49 offen
    s_mov_b64 exec, -1
    buffer_load_dword v57, v54, s[20:23], s50 offen nt
    s_waitcnt vmcnt(0)
    v_readlane_b32 s55, v57, 32
    s_mov_b32 exec_lo, 0
    v_mov_b32 v57, 0
    s_mov_b32 exec_lo, -1
    s_nop 1
    v_add_u32_dpp v57, v57, v57 row_ror:8 row_mask:0xf bank_mask:0xf
    s_nop 1
    v_add_u32_dpp v57, v57, v57 row_ror:4 row_mask:0xf bank_mask:0xf
    s_nop 1
    v_add_u32_dpp v57, v57, v57 row_ror:2 row_mask:0xf bank_mask:0xf
    s_nop 1
    v_add_u32_dpp v57, v57, v57 row_ror:1 row_mask:0xf bank_mask:0xf
    s_nop 1
    v_add_u32_dpp v57, v57, v57 row_bcast:15 row_mask:0xa bank_mask:0xf
    s_nop 1
    v_add_u32_dpp v57, v57, v57 row_bcast:31 row_mask:0xc bank_mask:0xf
    s_nop 1
    v_readlane_b32 s53, v57, 63
    s_nop 1
    s_lshl_b32 s53, s53, 1
    s_cmp_le_u32 s48, s35
    s_cbranch_scc0 L_nolead_28
    s_mov_b32 s35, 0
    v_mov_b32 v58, s53
    s_mov_b64 exec, 1
    buffer_store_dword v58, v9, s[20:23], s57 offen sc1
    s_mov_b64 exec, -1
    v_and_b32 v58, 7, v0
    v_lshlrev_b32 v58, 8, v58
    s_mov_b32 s32, 262144
    buffer_load_dword v59, v58, s[20:23], s32 offen sc1
    s_waitcnt vmcnt(0)
    v_add_u32_dpp v59, v59, v59 row_ror:4 row_mask:0xf bank_mask:0xf
    s_nop 1
    v_add_u32_dpp v59, v59, v59 row_ror:2 row_mask:0xf bank_mask:0xf
    s_nop 1
    v_add_u32_dpp v59, v59, v59 row_ror:1 row_mask:0xf bank_mask:0xf
    s_nop 1
    v_readfirstlane_b32 s32, v59
    s_nop 1
    s_lshr_b32 s32, s32, 3
    s_sub_u32 s55, s32, s53
    s_add_u32 s55, s55, 1536
    v_mov_b32 v58, s55
    s_mov_b64 exec, 1
    buffer_store_dword v58, v9, s[20:23], s50 offen offset:128
    s_mov_b64 exec, -1
L_nolead_28:
    s_sub_u32 s54, s52, s51
    s_lshl_b32 s54, s54, 6
    s_add_u32 s54, s54, s53
    s_add_u32 s54, s54, s55
    s_add_u32 s54, s54, 512
    s_mov_b32 s51, s52
    v_lshlrev_b32 v55, 8, v55
    v_sub_u32 v55, s54, v55
    v_ashrrev_i32 v55, 10, v55
    v_add_u32 v55, 5, v55
    v_max_i32 v55, 5, v55
    v_min_i32 v55, 7, v55
    ds_write_b32 v53, v55
    s_sub_u32 s48, s48, 1
    s_cmp_lg_u32 s48, 0
    s_cbranch_scc1 L_mon_26
L_mon_done_27:
    v_mov_b32 v56, 0x400
    s_mov_b64 exec, 1
    buffer_store_dword v56, v9, s[20:23], s49 offen
    s_mov_b64 exec, -1
    s_cmp_ge_u32 s2, 248
    s_cbranch_scc0 L_nolead_29
    v_mov_b32 v58, 0x10000
    s_mov_b64 exec, 1
    buffer_store_dword v58, v9, s[20:23], s57 offen sc1
    s_mov_b64 exec, -1
L_nolead_29:
L_toB2b_20:
    s_waitcnt vmcnt(0)
    v_and_b32 v8, 7, v1
    v_lshlrev_b32 v8, 2, v8
    v_add_u32 v8, v8, v2
    v_lshlrev_b32 v8, 2, v8
    s_lshl_b32 s48, s5, 7
    v_add_u32 v8, s48, v8
    v_mov_b32 v9, 2064
    v_lshlrev_b32 v10, 5, v1
    v_and_b32 v11, 1, v2
    v_lshlrev_b32 v11, 4, v11
    v_add_u32 v10, v10, v11
    s_mul_i32 s48, s5, 2560
    v_add_u32 v10, s48, v10
    s_mul_i32 s48, s5, 640
    v_lshlrev_b32 v11, 4, v0
    v_add_u32 v11, s48, v11
    s_mul_i32 s49, s47, 2560
    s_add_u32 s49, s49, 1048576
    s_barrier
    ds_read_b128 v[52:55], v9
    ds_read_b32 v56, v8 offset:4096
    ds_read_b32 v57, v8 offset:4608
    ds_read_b32 v58, v8 offset:5120
    ds_read_b32 v59, v8 offset:5632
    s_waitcnt lgkmcnt(0)
    v_mul_f32 v56, v52, v56
    v_mul_f32 v58, v54, v58
    v_fmac_f32 v56, v53, v57
    v_fmac_f32 v58, v55, v59
    v_add_f32 v56, v56, v58
    v_cvt_pk_bf16_f32 v56, v56, v56
    s_nop 1
    v_and_b32_dpp v20, v56, v4 row_newbcast:0 row_mask:0xf bank_mask:0xf
    v_and_b32_dpp v21, v56, v5 row_newbcast:0 row_mask:0xf bank_mask:0xf
    v_and_b32_dpp v22, v56, v6 row_newbcast:0 row_mask:0xf bank_mask:0xf
    v_and_b32_dpp v23, v56, v7 row_newbcast:0 row_mask:0xf bank_mask:0xf
    v_and_b32_dpp v24, v56, v4 row_newbcast:1 row_mask:0xf bank_mask:0xf
    v_and_b32_dpp v25, v56, v5 row_newbcast:1 row_mask:0xf bank_mask:0xf
    v_and_b32_dpp v26, v56, v6 row_newbcast:1 row_mask:0xf bank_mask:0xf
    v_and_b32_dpp v27, v56, v7 row_newbcast:1 row_mask:0xf bank_mask:0xf
    v_mfma_f32_16x16x32_bf16 v[32:35], v[20:23], v[64:67], v[32:35]
    v_mfma_f32_16x16x32_bf16 v[36:39], v[20:23], v[68:71], v[36:39]
    v_mfma_f32_16x16x32_bf16 v[40:43], v[20:23], v[72:75], v[40:43]
    v_mfma_f32_16x16x32_bf16 v[44:47], v[20:23], v[76:79], v[44:47]
    v_mfma_f32_16x16x32_bf16 v[48:51], v[20:23], v[80:83], v[48:51]
    v_and_b32_dpp v20, v56, v4 row_newbcast:2 row_mask:0xf bank_mask:0xf
    v_and_b32_dpp v21, v56, v5 row_newbcast:2 row_mask:0xf bank_mask:0xf
    v_and_b32_dpp v22, v56, v6 row_newbcast:2 row_mask:0xf bank_mask:0xf
    v_and_b32_dpp v23, v56, v7 row_newbcast:2 row_mask:0xf bank_mask:0xf
    v_mfma_f32_16x16x32_bf16 v[32:35], v[24:27], v[84:87], v[32:35]
    v_mfma_f32_16x16x32_bf16 v[36:39], v[24:27], v[88:91], v[36:39]
    v_mfma_f32_16x16x32_bf16 v[40:43], v[24:27], v[92:95], v[40:43]
    v_mfma_f32_16x16x32_bf16 v[44:47], v[24:27], v[96:99], v[44:47]
    v_mfma_f32_16x16x32_bf16 v[48:51], v[24:27], v[100:103], v[48:51]
    v_and_b32_dpp v24, v56, v4 row_newbcast:3 row_mask:0xf bank_mask:0xf
    v_and_b32_dpp v25, v56, v5 row_newbcast:3 row_mask:0xf bank_mask:0xf
    v_and_b32_dpp v26, v56, v6 row_newbcast:3 row_mask:0xf bank_mask:0xf
    v_and_b32_dpp v27, v56, v7 row_newbcast:3 row_mask:0xf bank_mask:0xf
    v_mfma_f32_16x16x32_bf16 v[32:35], v[20:23], v[104:107], v[32:35]
    v_mfma_f32_16x16x32_bf16 v[36:39], v[20:23], v[108:111], v[36:39]
    v_mfma_f32_16x16x32_bf16 v[40:43], v[20:23], v[112:115], v[40:43]
    v_mfma_f32_16x16x32_bf16 v[44:47], v[20:23], v[116:119], v[44:47]
    v_mfma_f32_16x16x32_bf16 v[48:51], v[20:23], v[120:123], v[48:51]
    v_and_b32_dpp v20, v56, v4 row_newbcast:4 row_mask:0xf bank_mask:0xf
    v_and_b32_dpp v21, v56, v5 row_newbcast:4 row_mask:0xf bank_mask:0xf
    v_and_b32_dpp v22, v56, v6 row_newbcast:4 row_mask:0xf bank_mask:0xf
    v_and_b32_dpp v23, v56, v7 row_newbcast:4 row_mask:0xf bank_mask:0xf
    v_mfma_f32_16x16x32_bf16 v[32:35], v[24:27], v[124:127], v[32:35]
    v_mfma_f32_16x16x32_bf16 v[36:39], v[24:27], v[128:131], v[36:39]
    v_mfma_f32_16x16x32_bf16 v[40:43], v[24:27], v[132:135], v[40:43]
    v_mfma_f32_16x16x32_bf16 v[44:47], v[24:27], v[136:139], v[44:47]
    v_mfma_f32_16x16x32_bf16 v[48:51], v[24:27], v[140:143], v[48:51]
    v_and_b32_dpp v24, v56, v4 row_newbcast:5 row_mask:0xf bank_mask:0xf
    v_and_b32_dpp v25, v56, v5 row_newbcast:5 row_mask:0xf bank_mask:0xf
    v_and_b32_dpp v26, v56, v6 row_newbcast:5 row_mask:0xf bank_mask:0xf
    v_and_b32_dpp v27, v56, v7 row_newbcast:5 row_mask:0xf bank_mask:0xf
    v_mfma_f32_16x16x32_bf16 v[32:35], v[20:23], v[144:147], v[32:35]
    v_mfma_f32_16x16x32_bf16 v[36:39], v[20:23], v[148:151], v[36:39]
    v_mfma_f32_16x16x32_bf16 v[40:43], v[20:23], v[152:155], v[40:43]
    v_mfma_f32_16x16x32_bf16 v[44:47], v[20:23], v[156:159], v[44:47]
    v_mfma_f32_16x16x32_bf16 v[48:51], v[20:23], v[160:163], v[48:51]
    v_and_b32_dpp v20, v56, v4 row_newbcast:6 row_mask:0xf bank_mask:0xf
    v_and_b32_dpp v21, v56, v5 row_newbcast:6 row_mask:0xf bank_mask:0xf
    v_and_b32_dpp v22, v56, v6 row_newbcast:6 row_mask:0xf bank_mask:0xf
    v_and_b32_dpp v23, v56, v7 row_newbcast:6 row_mask:0xf bank_mask:0xf
    v_mfma_f32_16x16x32_bf16 v[32:35], v[24:27], v[164:167], v[32:35]
    v_mfma_f32_16x16x32_bf16 v[36:39], v[24:27], v[168:171], v[36:39]
    v_mfma_f32_16x16x32_bf16 v[40:43], v[24:27], v[172:175], v[40:43]
    v_mfma_f32_16x16x32_bf16 v[44:47], v[24:27], v[176:179], v[44:47]
    v_mfma_f32_16x16x32_bf16 v[48:51], v[24:27], v[180:183], v[48:51]
    v_and_b32_dpp v24, v56, v4 row_newbcast:7 row_mask:0xf bank_mask:0xf
    v_and_b32_dpp v25, v56, v5 row_newbcast:7 row_mask:0xf bank_mask:0xf
    v_and_b32_dpp v26, v56, v6 row_newbcast:7 row_mask:0xf bank_mask:0xf
    v_and_b32_dpp v27, v56, v7 row_newbcast:7 row_mask:0xf bank_mask:0xf
    v_mfma_f32_16x16x32_bf16 v[32:35], v[20:23], v[184:187], v[32:35]
    v_mfma_f32_16x16x32_bf16 v[36:39], v[20:23], v[188:191], v[36:39]
    v_mfma_f32_16x16x32_bf16 v[40:43], v[20:23], v[192:195], v[40:43]
    v_mfma_f32_16x16x32_bf16 v[44:47], v[20:23], v[196:199], v[44:47]
    v_mfma_f32_16x16x32_bf16 v[48:51], v[20:23], v[200:203], v[48:51]
    s_nop 1
    v_mfma_f32_16x16x32_bf16 v[32:35], v[24:27], v[204:207], v[32:35]
    v_mfma_f32_16x16x32_bf16 v[36:39], v[24:27], v[208:211], v[36:39]
    v_mfma_f32_16x16x32_bf16 v[40:43], v[24:27], v[212:215], v[40:43]
    v_mfma_f32_16x16x32_bf16 v[44:47], v[24:27], v[216:219], v[44:47]
    v_mfma_f32_16x16x32_bf16 v[48:51], v[24:27], v[220:223], v[48:51]
    s_nop 3
    ds_write_b128 v10, v[32:35] offset:6144
    ds_write_b128 v10, v[36:39] offset:6656
    ds_write_b128 v10, v[40:43] offset:7168
    ds_write_b128 v10, v[44:47] offset:7680
    s_nop 3
    ds_write_b128 v10, v[48:51] offset:8192
    s_waitcnt lgkmcnt(0)
    s_barrier
    s_mov_b32 exec_hi, 0xff
    ds_read_b128 v[64:67], v11 offset:6144
    ds_read_b128 v[68:71], v11 offset:8704
    ds_read_b128 v[72:75], v11 offset:11264
    ds_read_b128 v[76:79], v11 offset:13824
    s_waitcnt lgkmcnt(0)
    v_pk_add_f32 v[64:65], v[64:65], v[68:69]
    v_pk_add_f32 v[66:67], v[66:67], v[70:71]
    v_pk_add_f32 v[72:73], v[72:73], v[76:77]
    v_pk_add_f32 v[74:75], v[74:75], v[78:79]
    v_pk_add_f32 v[64:65], v[64:65], v[72:73]
    v_pk_add_f32 v[66:67], v[66:67], v[74:75]
    buffer_store_dwordx4 v[64:67], v11, s[20:23], s49 offen sc1
    s_mov_b64 exec, -1
    s_cmp_eq_u32 s5, 0
    s_cbranch_scc0 L_fin_30
    s_cmp_lt_u32 s2, 80
    s_cbranch_scc0 L_fin_30
    v_lshrrev_b32 v58, 3, v0
    v_and_b32 v59, 7, v0
    v_mul_u32_u24 v60, 2560, v58
    v_lshlrev_b32 v61, 4, v59
    v_add_u32 v60, v60, v61
    s_mul_i32 s48, s62, 163840
    s_lshl_b32 s49, s63, 7
    s_add_u32 s48, s48, s49
    s_add_u32 s48, s48, 1048576
    s_add_u32 s49, s48, 20480
    s_add_u32 s50, s49, 20480
    s_add_u32 s51, s50, 20480
    s_add_u32 s52, s51, 20480
    s_add_u32 s53, s52, 20480
    s_add_u32 s54, s53, 20480
    s_add_u32 s55, s54, 20480
    s_mov_b32 s56, 200000
    buffer_load_dwordx4 v[64:67], v60, s[20:23], s48 offen sc1
    buffer_load_dwordx4 v[68:71], v60, s[20:23], s49 offen sc1
    buffer_load_dwordx4 v[72:75], v60, s[20:23], s50 offen sc1
    buffer_load_dwordx4 v[76:79], v60, s[20:23], s51 offen sc1
    buffer_load_dwordx4 v[80:83], v60, s[20:23], s52 offen sc1
    buffer_load_dwordx4 v[84:87], v60, s[20:23], s53 offen sc1
    buffer_load_dwordx4 v[88:91], v60, s[20:23], s54 offen sc1
    buffer_load_dwordx4 v[92:95], v60, s[20:23], s55 offen sc1
    buffer_load_dwordx4 v[96:99], v60, s[20:23], s48 offen sc1
    buffer_load_dwordx4 v[100:103], v60, s[20:23], s49 offen sc1
    buffer_load_dwordx4 v[104:107], v60, s[20:23], s50 offen sc1
    buffer_load_dwordx4 v[108:111], v60, s[20:23], s51 offen sc1
    buffer_load_dwordx4 v[112:115], v60, s[20:23], s52 offen sc1
    buffer_load_dwordx4 v[116:119], v60, s[20:23], s53 offen sc1
    buffer_load_dwordx4 v[120:123], v60, s[20:23], s54 offen sc1
    buffer_load_dwordx4 v[124:127], v60, s[20:23], s55 offen sc1
    buffer_load_dwordx4 v[128:131], v60, s[20:23], s48 offen sc1
    buffer_load_dwordx4 v[132:135], v60, s[20:23], s49 offen sc1
    buffer_load_dwordx4 v[136:139], v60, s[20:23], s50 offen sc1
    buffer_load_dwordx4 v[140:143], v60, s[20:23], s51 offen sc1
    buffer_load_dwordx4 v[144:147], v60, s[20:23], s52 offen sc1
    buffer_load_dwordx4 v[148:151], v60, s[20:23], s53 offen sc1
    buffer_load_dwordx4 v[152:155], v60, s[20:23], s54 offen sc1
    buffer_load_dwordx4 v[156:159], v60, s[20:23], s55 offen sc1
L_y_31:
    s_waitcnt vmcnt(16)
    v_pk_add_f32 v[64:65], v[64:65], v[80:81]
    v_pk_add_f32 v[66:67], v[66:67], v[82:83]
    v_pk_add_f32 v[68:69], v[68:69], v[84:85]
    v_pk_add_f32 v[70:71], v[70:71], v[86:87]
    v_pk_add_f32 v[72:73], v[72:73], v[88:89]
    v_pk_add_f32 v[74:75], v[74:75], v[90:91]
    v_pk_add_f32 v[76:77], v[76:77], v[92:93]
    v_pk_add_f32 v[78:79], v[78:79], v[94:95]
    v_pk_add_f32 v[64:65], v[64:65], v[72:73]
    v_pk_add_f32 v[66:67], v[66:67], v[74:75]
    v_pk_add_f32 v[68:69], v[68:69], v[76:77]
    v_pk_add_f32 v[70:71], v[70:71], v[78:79]
    v_pk_add_f32 v[64:65], v[64:65], v[68:69]
    v_pk_add_f32 v[66:67], v[66:67], v[70:71]
    v_add_f32 v68, v64, v65
    v_add_f32 v69, v66, v67
    v_add_f32 v68, v68, v69
    v_cmp_u_f32 vcc, v68, v68
    s_cbranch_vccz L_ydone_33
    buffer_load_dwordx4 v[64:67], v60, s[20:23], s48 offen sc1
    buffer_load_dwordx4 v[68:71], v60, s[20:23], s49 offen sc1
    buffer_load_dwordx4 v[72:75], v60, s[20:23], s50 offen sc1
    buffer_load_dwordx4 v[76:79], v60, s[20:23], s51 offen sc1
    buffer_load_dwordx4 v[80:83], v60, s[20:23], s52 offen sc1
    buffer_load_dwordx4 v[84:87], v60, s[20:23], s53 offen sc1
    buffer_load_dwordx4 v[88:91], v60, s[20:23], s54 offen sc1
    buffer_load_dwordx4 v[92:95], v60, s[20:23], s55 offen sc1
    s_waitcnt vmcnt(16)
    v_pk_add_f32 v[96:97], v[96:97], v[112:113]
    v_pk_add_f32 v[98:99], v[98:99], v[114:115]
    v_pk_add_f32 v[100:101], v[100:101], v[116:117]
    v_pk_add_f32 v[102:103], v[102:103], v[118:119]
    v_pk_add_f32 v[104:105], v[104:105], v[120:121]
    v_pk_add_f32 v[106:107], v[106:107], v[122:123]
    v_pk_add_f32 v[108:109], v[108:109], v[124:125]
    v_pk_add_f32 v[110:111], v[110:111], v[126:127]
    v_pk_add_f32 v[96:97], v[96:97], v[104:105]
    v_pk_add_f32 v[98:99], v[98:99], v[106:107]
    v_pk_add_f32 v[100:101], v[100:101], v[108:109]
    v_pk_add_f32 v[102:103], v[102:103], v[110:111]
    v_pk_add_f32 v[96:97], v[96:97], v[100:101]
    v_pk_add_f32 v[98:99], v[98:99], v[102:103]
    v_add_f32 v100, v96, v97
    v_add_f32 v101, v98, v99
    v_add_f32 v100, v100, v101
    v_cmp_u_f32 vcc, v100, v100
    s_cbranch_vccz L_ydone_34
    buffer_load_dwordx4 v[96:99], v60, s[20:23], s48 offen sc1
    buffer_load_dwordx4 v[100:103], v60, s[20:23], s49 offen sc1
    buffer_load_dwordx4 v[104:107], v60, s[20:23], s50 offen sc1
    buffer_load_dwordx4 v[108:111], v60, s[20:23], s51 offen sc1
    buffer_load_dwordx4 v[112:115], v60, s[20:23], s52 offen sc1
    buffer_load_dwordx4 v[116:119], v60, s[20:23], s53 offen sc1
    buffer_load_dwordx4 v[120:123], v60, s[20:23], s54 offen sc1
    buffer_load_dwordx4 v[124:127], v60, s[20:23], s55 offen sc1
    s_waitcnt vmcnt(16)
    v_pk_add_f32 v[128:129], v[128:129], v[144:145]
    v_pk_add_f32 v[130:131], v[130:131], v[146:147]
    v_pk_add_f32 v[132:133], v[132:133], v[148:149]
    v_pk_add_f32 v[134:135], v[134:135], v[150:151]
    v_pk_add_f32 v[136:137], v[136:137], v[152:153]
    v_pk_add_f32 v[138:139], v[138:139], v[154:155]
    v_pk_add_f32 v[140:141], v[140:141], v[156:157]
    v_pk_add_f32 v[142:143], v[142:143], v[158:159]
    v_pk_add_f32 v[128:129], v[128:129], v[136:137]
    v_pk_add_f32 v[130:131], v[130:131], v[138:139]
    v_pk_add_f32 v[132:133], v[132:133], v[140:141]
    v_pk_add_f32 v[134:135], v[134:135], v[142:143]
    v_pk_add_f32 v[128:129], v[128:129], v[132:133]
    v_pk_add_f32 v[130:131], v[130:131], v[134:135]
    v_add_f32 v132, v128, v129
    v_add_f32 v133, v130, v131
    v_add_f32 v132, v132, v133
    v_cmp_u_f32 vcc, v132, v132
    s_cbranch_vccz L_ydone_35
    buffer_load_dwordx4 v[128:131], v60, s[20:23], s48 offen sc1
    buffer_load_dwordx4 v[132:135], v60, s[20:23], s49 offen sc1
    buffer_load_dwordx4 v[136:139], v60, s[20:23], s50 offen sc1
    buffer_load_dwordx4 v[140:143], v60, s[20:23], s51 offen sc1
    buffer_load_dwordx4 v[144:147], v60, s[20:23], s52 offen sc1
    buffer_load_dwordx4 v[148:151], v60, s[20:23], s53 offen sc1
    buffer_load_dwordx4 v[152:155], v60, s[20:23], s54 offen sc1
    buffer_load_dwordx4 v[156:159], v60, s[20:23], s55 offen sc1
    s_sub_u32 s56, s56, 1
    s_cmp_lg_u32 s56, 0
    s_cbranch_scc1 L_y_31
L_ydone_33:
    v_mov_b32 v160, v64
    v_mov_b32 v161, v65
    v_mov_b32 v162, v66
    v_mov_b32 v163, v67
    s_branch L_yfin_32
L_ydone_34:
    v_mov_b32 v160, v96
    v_mov_b32 v161, v97
    v_mov_b32 v162, v98
    v_mov_b32 v163, v99
    s_branch L_yfin_32
L_ydone_35:
    v_mov_b32 v160, v128
    v_mov_b32 v161, v129
    v_mov_b32 v162, v130
    v_mov_b32 v163, v131
L_yfin_32:
    s_nop 1
    v_add_f32_dpp v160, v160, v160 row_ror:8 row_mask:0xf bank_mask:0xf
    v_add_f32_dpp v161, v161, v161 row_ror:8 row_mask:0xf bank_mask:0xf
    v_add_f32_dpp v162, v162, v162 row_ror:8 row_mask:0xf bank_mask:0xf
    v_add_f32_dpp v163, v163, v163 row_ror:8 row_mask:0xf bank_mask:0xf
    v_mov_b32 v164, v160
    v_mov_b32 v165, v161
    v_mov_b32 v166, v162
    v_mov_b32 v167, v163
    s_nop 1
    v_permlane16_swap_b32 v164, v160
    v_permlane16_swap_b32 v165, v161
    v_permlane16_swap_b32 v166, v162
    v_permlane16_swap_b32 v167, v163
    s_nop 1
    v_add_f32 v160, v160, v164
    v_add_f32 v161, v161, v165
    v_add_f32 v162, v162, v166
    v_add_f32 v163, v163, v167
    v_mov_b32 v164, v160
    v_mov_b32 v165, v161
    v_mov_b32 v166, v162
    v_mov_b32 v167, v163
    s_nop 1
    v_permlane32_swap_b32 v164, v160
    v_permlane32_swap_b32 v165, v161
    v_permlane32_swap_b32 v166, v162
    v_permlane32_swap_b32 v167, v163
    s_nop 1
    v_add_f32 v160, v160, v164
    v_add_f32 v161, v161, v165
    v_add_f32 v162, v162, v166
    v_add_f32 v163, v163, v167
    v_add_f32 v160, v244, v160
    v_add_f32 v161, v245, v161
    v_add_f32 v162, v246, v162
    v_add_f32 v163, v247, v163
    v_cvt_pk_bf16_f32 v160, v160, v161
    v_cvt_pk_bf16_f32 v161, v162, v163
    s_mul_i32 s48, s62, 1280
    s_lshl_b32 s49, s63, 6
    s_add_u32 s57, s48, s49
    v_lshlrev_b32 v61, 3, v59
    s_mov_b64 exec, 0xff
    buffer_store_dwordx2 v[160:161], v61, s[28:31], s57 offen
    s_mov_b64 exec, -1
L_fin_30:
    s_endpgm
L_exit:
    s_endpgm
.section .rodata,"a"
.p2align 6
.amdhsa_kernel parallel_sum__gqa_block_cached__glu_gated_reglu__decode_kernel
  .amdhsa_next_free_vgpr 256
  .amdhsa_next_free_sgpr 102
  .amdhsa_accum_offset 256
  .amdhsa_group_segment_fixed_size 0
  .amdhsa_kernarg_size 96
  .amdhsa_user_sgpr_count 2
  .amdhsa_user_sgpr_kernarg_segment_ptr 1
  .amdhsa_system_sgpr_workgroup_id_x 1
.end_amdhsa_kernel
```
